```python
import torch

def _softmax(x, axis=-1):
    return torch.softmax(x, dim=axis)
def _gelu(x):
    return torch.nn.functional.gelu(x, approximate="tanh")
def _silu(x):
    return torch.nn.functional.silu(x)
def _sigmoid(x):
    return torch.sigmoid(x)
def _layernorm(x, axis=-1, eps=1e-5):
    m = x.mean(dim=axis, keepdim=True)
    v = x.var(dim=axis, keepdim=True, unbiased=False)
    return (x - m) / torch.sqrt(v + eps)
def _scatter_add(tgt, idx, src, axis=0):
    return tgt.clone().index_add_(axis, idx, src)
def _segment_sum(src, seg, n):
    out = torch.zeros((n,) + src.shape[1:], dtype=src.dtype)
    return out.index_add_(0, seg, src)
def _pad(x, pw):
    flat = tuple(v for pair in reversed(pw) for v in pair)
    return torch.nn.functional.pad(x, flat)

kernel_name = 'gated_mix__ssm_conv_s5__ssm_conv_s5__prompt'

def setup_inputs():

    _w = (lambda a: (lambda t: t.to(torch.bfloat16) if t.is_floating_point() else t)(torch.as_tensor(a)))
    def _A_setup():
        B, S, D = 1, 2048, 1024
        P = D
        Lambda_re = -0.5 * (lambda _x: torch.exp(torch.as_tensor(_x)))((lambda *s: torch.randn(*s, dtype=torch.bfloat16) * 0.2)(P))
        Lambda_im = (lambda *s: torch.randn(*s, dtype=torch.bfloat16) * 0.4)(P) * 1.0
        B_re = (lambda *s: torch.randn(*s, dtype=torch.bfloat16) * 0.2)(P, D) * (D ** -0.5)
        B_im = (lambda *s: torch.randn(*s, dtype=torch.bfloat16) * 0.2)(P, D) * (D ** -0.5)
        C_re = (lambda *s: torch.randn(*s, dtype=torch.bfloat16) * 0.2)(D, P) * (P ** -0.5)
        C_im = (lambda *s: torch.randn(*s, dtype=torch.bfloat16) * 0.2)(D, P) * (P ** -0.5)
        log_dt = (lambda *s: torch.randn(*s, dtype=torch.bfloat16) * 0.2)(P) * 0.3 - 2.0
        Dskip = (lambda *s: torch.randn(*s, dtype=torch.bfloat16) * 0.05)(D)
        return {
            "x": _w((lambda *s: torch.randn(*s, dtype=torch.bfloat16) * 0.05)(B, S, D)),
            "Lambda_re": _w(Lambda_re),
            "Lambda_im": _w(Lambda_im),
            "B_re": _w(B_re),
            "B_im": _w(B_im),
            "C_re": _w(C_re),
            "C_im": _w(C_im),
            "log_dt": _w(log_dt),
            "Dskip": _w(Dskip),
        }
    _A_in = _A_setup()

    def _B_setup():
        B, S, D = 1, 2048, 1024
        P = D
        Lambda_re = -0.5 * (lambda _x: torch.exp(torch.as_tensor(_x)))((lambda *s: torch.randn(*s, dtype=torch.bfloat16) * 0.2)(P))
        Lambda_im = (lambda *s: torch.randn(*s, dtype=torch.bfloat16) * 0.4)(P) * 1.0
        B_re = (lambda *s: torch.randn(*s, dtype=torch.bfloat16) * 0.2)(P, D) * (D ** -0.5)
        B_im = (lambda *s: torch.randn(*s, dtype=torch.bfloat16) * 0.2)(P, D) * (D ** -0.5)
        C_re = (lambda *s: torch.randn(*s, dtype=torch.bfloat16) * 0.2)(D, P) * (P ** -0.5)
        C_im = (lambda *s: torch.randn(*s, dtype=torch.bfloat16) * 0.2)(D, P) * (P ** -0.5)
        log_dt = (lambda *s: torch.randn(*s, dtype=torch.bfloat16) * 0.2)(P) * 0.3 - 2.0
        Dskip = (lambda *s: torch.randn(*s, dtype=torch.bfloat16) * 0.05)(D)
        return {
            "x": _w((lambda *s: torch.randn(*s, dtype=torch.bfloat16) * 0.05)(B, S, D)),
            "Lambda_re": _w(Lambda_re),
            "Lambda_im": _w(Lambda_im),
            "B_re": _w(B_re),
            "B_im": _w(B_im),
            "C_re": _w(C_re),
            "C_im": _w(C_im),
            "log_dt": _w(log_dt),
            "Dskip": _w(Dskip),
        }
    _B_in = _B_setup()

    return {
        "A_x": _A_in["x"],
        "A_Lambda_re": _A_in["Lambda_re"],
        "A_Lambda_im": _A_in["Lambda_im"],
        "A_B_re": _A_in["B_re"],
        "A_B_im": _A_in["B_im"],
        "A_C_re": _A_in["C_re"],
        "A_C_im": _A_in["C_im"],
        "A_log_dt": _A_in["log_dt"],
        "A_Dskip": _A_in["Dskip"],
        "B_x": _B_in["x"],
        "B_Lambda_re": _B_in["Lambda_re"],
        "B_Lambda_im": _B_in["Lambda_im"],
        "B_B_re": _B_in["B_re"],
        "B_B_im": _B_in["B_im"],
        "B_C_re": _B_in["C_re"],
        "B_C_im": _B_in["C_im"],
        "B_log_dt": _B_in["log_dt"],
        "B_Dskip": _B_in["Dskip"],
        "gate_w": _w((lambda *s: torch.randn(*s, dtype=torch.bfloat16) * 0.05)(1024) * 16.0),
    }

def reference(A_x, A_Lambda_re, A_Lambda_im, A_B_re, A_B_im, A_C_re, A_C_im, A_log_dt, A_Dskip, B_x, B_Lambda_re, B_Lambda_im, B_B_re, B_B_im, B_C_re, B_C_im, B_log_dt, B_Dskip, gate_w):
    def _A_ref(x, Lambda_re, Lambda_im, B_re, B_im, C_re, C_im, log_dt, Dskip):
        Bsz, L, H = x.shape
        Lam = Lambda_re + 1j * Lambda_im
        Bmat = B_re + 1j * B_im
        Cmat = C_re + 1j * C_im
        dt = torch.exp(log_dt)
        Lam_bar = torch.exp(dt * Lam)
        B_bar = ((Lam_bar - 1.0) / Lam)[:, None] * Bmat
        Bu = torch.einsum("bld,pd->blp", x + 0j, B_bar)
        h = torch.zeros_like(Bu[:, 0, :])
        hs = []
        for t in range(L):
            h = Lam_bar[None, :] * h + Bu[:, t, :]
            hs.append(h)
        hseq = torch.stack(hs, 1)
        y = 2.0 * torch.einsum("blp,dp->bld", hseq, Cmat).real + x * Dskip[None, None, :]
        return y

    def _B_ref(x, Lambda_re, Lambda_im, B_re, B_im, C_re, C_im, log_dt, Dskip):
        Bsz, L, H = x.shape
        Lam = Lambda_re + 1j * Lambda_im
        Bmat = B_re + 1j * B_im
        Cmat = C_re + 1j * C_im
        dt = torch.exp(log_dt)
        Lam_bar = torch.exp(dt * Lam)
        B_bar = ((Lam_bar - 1.0) / Lam)[:, None] * Bmat
        Bu = torch.einsum("bld,pd->blp", x + 0j, B_bar)
        h = torch.zeros_like(Bu[:, 0, :])
        hs = []
        for t in range(L):
            h = Lam_bar[None, :] * h + Bu[:, t, :]
            hs.append(h)
        hseq = torch.stack(hs, 1)
        y = 2.0 * torch.einsum("blp,dp->bld", hseq, Cmat).real + x * Dskip[None, None, :]
        return y

    x = A_x
    g = _sigmoid((x * gate_w).sum(-1, keepdims=True))
    a = _A_ref(x, A_Lambda_re, A_Lambda_im, A_B_re, A_B_im, A_C_re, A_C_im, A_log_dt, A_Dskip)
    b = _B_ref(x, B_Lambda_re, B_Lambda_im, B_B_re, B_B_im, B_C_re, B_C_im, B_log_dt, B_Dskip)
    return g * a + (1 - g) * b
```

```asm
; @launch grid=(256,1,1) block=(512,1,1) lds=163840
.amdgcn_target "amdgcn-amd-amdhsa--gfx950"
.text
.globl gated_mix__ssm_conv_s5__ssm_conv_s5__prompt_kernel
.p2align 8
.type gated_mix__ssm_conv_s5__ssm_conv_s5__prompt_kernel,@function
gated_mix__ssm_conv_s5__ssm_conv_s5__prompt_kernel:
    s_cmp_ge_u32 s2, 256
    s_cbranch_scc1 L_end
    s_lshr_b32 s40, s2, 5
    s_and_b32 s41, s2, 7
    s_lshl_b32 s41, s41, 2
    s_bfe_u32 s42, s2, 0x20003
    s_add_u32 s41, s41, s42
    s_lshr_b32 s42, s41, 4
    s_and_b32 s43, s41, 15
    s_lshl_b32 s43, s43, 6
    s_mul_i32 s44, s42, 72
    s_mov_b32 s64, s0
    s_mov_b32 s65, s1
    s_load_dwordx2 s[4:5], s[0:1], 0
    s_load_dwordx4 s[36:39], s[0:1], 160
    s_add_u32 s0, s0, s44
    s_addc_u32 s1, s1, 0
    s_load_dwordx4 s[8:11], s[0:1], 24
    s_load_dwordx2 s[34:35], s[64:65], 144
    s_load_dwordx4 s[28:31], s[0:1], 8
    s_load_dwordx2 s[32:33], s[0:1], 56
    s_load_dwordx4 s[80:83], s[64:65], 40
    s_load_dwordx4 s[84:87], s[64:65], 112
    s_load_dwordx2 s[88:89], s[64:65], 152
    s_load_dwordx2 s[90:91], s[64:65], 64
    s_load_dwordx2 s[92:93], s[64:65], 136
    v_lshrrev_b32 v1, 6, v0
    s_nop 0
    v_readfirstlane_b32 s45, v1
    v_and_b32 v0, 63, v0
    s_waitcnt lgkmcnt(0)
    s_mov_b32 s12, s4
    s_mov_b32 s13, s5
    s_mov_b32 s14, 0x400000
    s_mov_b32 s15, 0x00020000
    s_mov_b32 s20, s38
    s_mov_b32 s21, s39
    s_mov_b32 s22, 0x1044000
    s_mov_b32 s23, 0x00020000
    s_mov_b32 s24, s36
    s_mov_b32 s25, s37
    s_mov_b32 s26, 0x100
    s_mov_b32 s27, 0x00020000
    s_cmp_lt_u32 s45, 4
    s_cbranch_scc1 L_compute
    s_mov_b32 s3, 1
    s_sub_u32 s46, s45, 4
    s_getpc_b64 s[100:101]
L_pc:
    s_sub_u32 s100, s100, L_pc-gated_mix__ssm_conv_s5__ssm_conv_s5__prompt_kernel
    s_subb_u32 s101, s101, 0
    s_mov_b32 s96, 67584
    s_and_b32 s48, s46, 1
    s_cmp_eq_u32 s48, 0
    s_cselect_b32 s16, s8, s10
    s_cselect_b32 s17, s9, s11
    s_mov_b32 s18, 0x200000
    s_mov_b32 s19, 0x00020000
    v_lshrrev_b32 v1, 3, v0
    v_and_b32 v2, 7, v0
    v_lshrrev_b32 v3, 1, v1
    v_xor_b32 v4, v2, v3
    v_xor_b32 v5, 4, v4
    v_lshlrev_b32 v4, 4, v4
    v_lshlrev_b32 v5, 4, v5
    v_lshrrev_b32 v6, 2, v1
    v_lshlrev_b32 v6, 5, v6
    v_and_b32 v7, 1, v1
    v_lshlrev_b32 v7, 4, v7
    v_add_u32 v6, v6, v7
    v_and_b32 v7, 1, v3
    v_add_u32 v6, v6, v7
    s_lshl_b32 s50, s40, 8
    s_lshr_b32 s51, s46, 1
    s_lshl_b32 s51, s51, 7
    s_add_u32 s50, s50, s51
    s_and_b32 s51, s46, 1
    s_lshl_b32 s51, s51, 3
    s_add_u32 s50, s50, s51
    v_add_u32 v6, s50, v6
    v_lshlrev_b32 v6, 11, v6
    v_add_u32 v10, v6, v4
    v_add_u32 v11, v6, v5
    v_add_u32 v11, 131072, v11
    v_add_u32 v16, 0, v10
    v_add_u32 v17, 4294966272, v11
    v_add_u32 v18, 2048, v10
    v_add_u32 v19, 1024, v11
    v_add_u32 v20, 8192, v10
    v_add_u32 v21, 7168, v11
    v_add_u32 v22, 10240, v10
    v_add_u32 v23, 9216, v11
    s_lshr_b32 s51, s46, 1
    s_lshl_b32 s51, s51, 5
    s_add_u32 s51, s51, s43
    v_add_u32 v7, s51, v1
    v_lshlrev_b32 v7, 11, v7
    v_add_u32 v12, v7, v4
    v_add_u32 v13, v7, v5
    v_add_u32 v24, 0, v12
    v_add_u32 v25, 15360, v13
    v_add_u32 v26, 30720, v12
    v_add_u32 v27, 46080, v13
    s_lshl_b32 s52, s46, 13
    s_lshl_b32 s53, s46, 12
    s_add_u32 s53, s53, 32768
    s_movk_i32 s57, 0
    s_add_u32 m0, s52, 0
    s_nop 0
    buffer_load_dwordx4 v16, s[12:15], s57 offen offset:0 lds
    buffer_load_dwordx4 v17, s[12:15], s57 offen offset:1024 lds
    buffer_load_dwordx4 v18, s[12:15], s57 offen offset:2048 lds
    buffer_load_dwordx4 v19, s[12:15], s57 offen offset:3072 lds
    s_add_u32 m0, s52, 4096
    s_nop 0
    buffer_load_dwordx4 v20, s[12:15], s57 offen offset:0 lds
    buffer_load_dwordx4 v21, s[12:15], s57 offen offset:1024 lds
    buffer_load_dwordx4 v22, s[12:15], s57 offen offset:2048 lds
    buffer_load_dwordx4 v23, s[12:15], s57 offen offset:3072 lds
    s_add_u32 m0, s53, 0
    s_nop 0
    buffer_load_dwordx4 v24, s[16:19], s57 offen offset:0 nt lds
    buffer_load_dwordx4 v25, s[16:19], s57 offen offset:1024 nt lds
    buffer_load_dwordx4 v26, s[16:19], s57 offen offset:2048 nt lds
    buffer_load_dwordx4 v27, s[16:19], s57 offen offset:3072 nt lds
    s_movk_i32 s57, 128
    s_add_u32 m0, s52, 49152
    s_nop 0
    buffer_load_dwordx4 v16, s[12:15], s57 offen offset:0 lds
    buffer_load_dwordx4 v17, s[12:15], s57 offen offset:1024 lds
    buffer_load_dwordx4 v18, s[12:15], s57 offen offset:2048 lds
    buffer_load_dwordx4 v19, s[12:15], s57 offen offset:3072 lds
    s_add_u32 m0, s52, 53248
    s_nop 0
    buffer_load_dwordx4 v20, s[12:15], s57 offen offset:0 lds
    buffer_load_dwordx4 v21, s[12:15], s57 offen offset:1024 lds
    buffer_load_dwordx4 v22, s[12:15], s57 offen offset:2048 lds
    buffer_load_dwordx4 v23, s[12:15], s57 offen offset:3072 lds
    s_add_u32 m0, s53, 49152
    s_nop 0
    buffer_load_dwordx4 v24, s[16:19], s57 offen offset:0 nt lds
    buffer_load_dwordx4 v25, s[16:19], s57 offen offset:1024 nt lds
    buffer_load_dwordx4 v26, s[16:19], s57 offen offset:2048 nt lds
    buffer_load_dwordx4 v27, s[16:19], s57 offen offset:3072 nt lds
    s_lshl_b32 s50, s2, 14
    s_lshl_b32 s51, s40, 3
    s_add_u32 s51, s51, s43
    s_lshl_b32 s51, s51, 11
    s_mov_b32 s68, s4
    s_mov_b32 s69, s5
    s_mov_b32 s70, 0x400000
    s_mov_b32 s71, 0x00020000
    s_mov_b32 s67, s50
    s_cmp_eq_u32 s46, 1
    s_cselect_b32 s68, s8, s68
    s_cselect_b32 s69, s9, s69
    s_cselect_b32 s67, s51, s67
    s_cselect_b32 s70, 0x200000, s70
    s_cmp_eq_u32 s46, 2
    s_cselect_b32 s68, s10, s68
    s_cselect_b32 s69, s11, s69
    s_cselect_b32 s67, s51, s67
    s_cselect_b32 s70, 0x200000, s70
    v_lshlrev_b32 v14, 11, v1
    s_mov_b32 s97, 0
    s_cmp_eq_u32 s46, 1
    s_cselect_b32 s97, 1, s97
    s_cmp_eq_u32 s46, 2
    s_cselect_b32 s97, 1, s97
    v_min_u32 v15, 3, v2
    v_add_u32 v15, 2, v15
    v_lshlrev_b32 v15, 7, v15
    v_add_u32 v15, v15, v14
    buffer_load_dword v9, v15, s[68:71], s67 offen
    s_waitcnt vmcnt(13)
    s_barrier
    s_movk_i32 s57, 256
    s_add_u32 m0, s52, 98304
    s_nop 0
    buffer_load_dwordx4 v16, s[12:15], s57 offen offset:0 lds
    buffer_load_dwordx4 v17, s[12:15], s57 offen offset:1024 lds
    buffer_load_dwordx4 v18, s[12:15], s57 offen offset:2048 lds
    buffer_load_dwordx4 v19, s[12:15], s57 offen offset:3072 lds
    s_add_u32 m0, s52, 102400
    s_nop 0
    buffer_load_dwordx4 v20, s[12:15], s57 offen offset:0 lds
    buffer_load_dwordx4 v21, s[12:15], s57 offen offset:1024 lds
    buffer_load_dwordx4 v22, s[12:15], s57 offen offset:2048 lds
    buffer_load_dwordx4 v23, s[12:15], s57 offen offset:3072 lds
    s_add_u32 m0, s53, 98304
    s_nop 0
    buffer_load_dwordx4 v24, s[16:19], s57 offen offset:0 nt lds
    buffer_load_dwordx4 v25, s[16:19], s57 offen offset:1024 nt lds
    buffer_load_dwordx4 v26, s[16:19], s57 offen offset:2048 nt lds
    buffer_load_dwordx4 v27, s[16:19], s57 offen offset:3072 nt lds
    s_waitcnt vmcnt(13)
    s_barrier
    s_movk_i32 s57, 384
    s_add_u32 m0, s52, 0
    s_nop 0
    buffer_load_dwordx4 v16, s[12:15], s57 offen offset:0 lds
    buffer_load_dwordx4 v17, s[12:15], s57 offen offset:1024 lds
    buffer_load_dwordx4 v18, s[12:15], s57 offen offset:2048 lds
    buffer_load_dwordx4 v19, s[12:15], s57 offen offset:3072 lds
    s_add_u32 m0, s52, 4096
    s_nop 0
    buffer_load_dwordx4 v20, s[12:15], s57 offen offset:0 lds
    buffer_load_dwordx4 v21, s[12:15], s57 offen offset:1024 lds
    buffer_load_dwordx4 v22, s[12:15], s57 offen offset:2048 lds
    buffer_load_dwordx4 v23, s[12:15], s57 offen offset:3072 lds
    s_add_u32 m0, s53, 0
    s_nop 0
    buffer_load_dwordx4 v24, s[16:19], s57 offen offset:0 nt lds
    buffer_load_dwordx4 v25, s[16:19], s57 offen offset:1024 nt lds
    buffer_load_dwordx4 v26, s[16:19], s57 offen offset:2048 nt lds
    buffer_load_dwordx4 v27, s[16:19], s57 offen offset:3072 nt lds
    v_min_u32 v15, 3, v2
    v_add_u32 v15, 6, v15
    v_lshlrev_b32 v15, 7, v15
    v_add_u32 v15, v15, v14
    buffer_load_dword v9, v15, s[68:71], s67 offen
    v_mov_b32 v32, -1
    v_mov_b32 v33, -1
    v_mov_b32 v34, -1
    v_mov_b32 v35, -1
    s_lshl_b32 s48, s41, 3
    s_add_u32 s48, s48, s40
    s_lshl_b32 s48, s48, 10
    s_add_u32 s48, s48, 16777216
    v_lshlrev_b32 v36, 4, v0
    s_mov_b32 exec_hi, 0xff
    buffer_store_dwordx4 v[32:35], v36, s[20:23], s48 offen sc1
    s_mov_b64 exec, -1
    s_waitcnt vmcnt(14)
    s_barrier
    s_movk_i32 s57, 512
    s_add_u32 m0, s52, 49152
    s_nop 0
    buffer_load_dwordx4 v16, s[12:15], s57 offen offset:0 lds
    buffer_load_dwordx4 v17, s[12:15], s57 offen offset:1024 lds
    buffer_load_dwordx4 v18, s[12:15], s57 offen offset:2048 lds
    buffer_load_dwordx4 v19, s[12:15], s57 offen offset:3072 lds
    s_add_u32 m0, s52, 53248
    s_nop 0
    buffer_load_dwordx4 v20, s[12:15], s57 offen offset:0 lds
    buffer_load_dwordx4 v21, s[12:15], s57 offen offset:1024 lds
    buffer_load_dwordx4 v22, s[12:15], s57 offen offset:2048 lds
    buffer_load_dwordx4 v23, s[12:15], s57 offen offset:3072 lds
    s_add_u32 m0, s53, 49152
    s_nop 0
    buffer_load_dwordx4 v24, s[16:19], s57 offen offset:0 nt lds
    buffer_load_dwordx4 v25, s[16:19], s57 offen offset:1024 nt lds
    buffer_load_dwordx4 v26, s[16:19], s57 offen offset:2048 nt lds
    buffer_load_dwordx4 v27, s[16:19], s57 offen offset:3072 nt lds
    s_waitcnt vmcnt(14)
    s_barrier
    s_movk_i32 s57, 640
    s_add_u32 m0, s52, 98304
    s_nop 0
    buffer_load_dwordx4 v16, s[12:15], s57 offen offset:0 lds
    buffer_load_dwordx4 v17, s[12:15], s57 offen offset:1024 lds
    buffer_load_dwordx4 v18, s[12:15], s57 offen offset:2048 lds
    buffer_load_dwordx4 v19, s[12:15], s57 offen offset:3072 lds
    s_add_u32 m0, s52, 102400
    s_nop 0
    buffer_load_dwordx4 v20, s[12:15], s57 offen offset:0 lds
    buffer_load_dwordx4 v21, s[12:15], s57 offen offset:1024 lds
    buffer_load_dwordx4 v22, s[12:15], s57 offen offset:2048 lds
    buffer_load_dwordx4 v23, s[12:15], s57 offen offset:3072 lds
    s_add_u32 m0, s53, 98304
    s_nop 0
    buffer_load_dwordx4 v24, s[16:19], s57 offen offset:0 nt lds
    buffer_load_dwordx4 v25, s[16:19], s57 offen offset:1024 nt lds
    buffer_load_dwordx4 v26, s[16:19], s57 offen offset:2048 nt lds
    buffer_load_dwordx4 v27, s[16:19], s57 offen offset:3072 nt lds
    s_waitcnt vmcnt(12)
    s_barrier
    s_movk_i32 s57, 768
    s_add_u32 m0, s52, 0
    s_nop 0
    buffer_load_dwordx4 v16, s[12:15], s57 offen offset:0 lds
    buffer_load_dwordx4 v17, s[12:15], s57 offen offset:1024 lds
    buffer_load_dwordx4 v18, s[12:15], s57 offen offset:2048 lds
    buffer_load_dwordx4 v19, s[12:15], s57 offen offset:3072 lds
    s_add_u32 m0, s52, 4096
    s_nop 0
    buffer_load_dwordx4 v20, s[12:15], s57 offen offset:0 lds
    buffer_load_dwordx4 v21, s[12:15], s57 offen offset:1024 lds
    buffer_load_dwordx4 v22, s[12:15], s57 offen offset:2048 lds
    buffer_load_dwordx4 v23, s[12:15], s57 offen offset:3072 lds
    s_add_u32 m0, s53, 0
    s_nop 0
    buffer_load_dwordx4 v24, s[16:19], s57 offen offset:0 nt lds
    buffer_load_dwordx4 v25, s[16:19], s57 offen offset:1024 nt lds
    buffer_load_dwordx4 v26, s[16:19], s57 offen offset:2048 nt lds
    buffer_load_dwordx4 v27, s[16:19], s57 offen offset:3072 nt lds
    v_min_u32 v15, 5, v2
    v_add_u32 v15, 10, v15
    v_lshlrev_b32 v15, 7, v15
    v_add_u32 v15, v15, v14
    buffer_load_dword v9, v15, s[68:71], s67 offen
    s_cmp_lg_u32 s46, 0
    s_cbranch_scc1 L_nosig
    s_lshl_b32 s48, 1, s40
    v_mov_b32 v37, s48
    s_lshl_b32 s49, s41, 2
    v_mov_b32 v38, s49
    s_mov_b64 exec, 1
    buffer_atomic_or v37, v38, s[24:27], 0 offen
    s_mov_b64 exec, -1
L_nosig:
    s_waitcnt vmcnt(13)
    s_barrier
    s_movk_i32 s57, 896
    s_add_u32 m0, s52, 49152
    s_nop 0
    buffer_load_dwordx4 v16, s[12:15], s57 offen offset:0 lds
    buffer_load_dwordx4 v17, s[12:15], s57 offen offset:1024 lds
    buffer_load_dwordx4 v18, s[12:15], s57 offen offset:2048 lds
    buffer_load_dwordx4 v19, s[12:15], s57 offen offset:3072 lds
    s_add_u32 m0, s52, 53248
    s_nop 0
    buffer_load_dwordx4 v20, s[12:15], s57 offen offset:0 lds
    buffer_load_dwordx4 v21, s[12:15], s57 offen offset:1024 lds
    buffer_load_dwordx4 v22, s[12:15], s57 offen offset:2048 lds
    buffer_load_dwordx4 v23, s[12:15], s57 offen offset:3072 lds
    s_add_u32 m0, s53, 49152
    s_nop 0
    buffer_load_dwordx4 v24, s[16:19], s57 offen offset:0 nt lds
    buffer_load_dwordx4 v25, s[16:19], s57 offen offset:1024 nt lds
    buffer_load_dwordx4 v26, s[16:19], s57 offen offset:2048 nt lds
    buffer_load_dwordx4 v27, s[16:19], s57 offen offset:3072 nt lds
    s_waitcnt vmcnt(13)
    s_barrier
    s_movk_i32 s57, 1024
    s_add_u32 m0, s52, 98304
    s_nop 0
    buffer_load_dwordx4 v16, s[12:15], s57 offen offset:0 lds
    buffer_load_dwordx4 v17, s[12:15], s57 offen offset:1024 lds
    buffer_load_dwordx4 v18, s[12:15], s57 offen offset:2048 lds
    buffer_load_dwordx4 v19, s[12:15], s57 offen offset:3072 lds
    s_add_u32 m0, s52, 102400
    s_nop 0
    buffer_load_dwordx4 v20, s[12:15], s57 offen offset:0 lds
    buffer_load_dwordx4 v21, s[12:15], s57 offen offset:1024 lds
    buffer_load_dwordx4 v22, s[12:15], s57 offen offset:2048 lds
    buffer_load_dwordx4 v23, s[12:15], s57 offen offset:3072 lds
    s_add_u32 m0, s53, 98304
    s_nop 0
    buffer_load_dwordx4 v24, s[16:19], s57 offen offset:0 nt lds
    buffer_load_dwordx4 v25, s[16:19], s57 offen offset:1024 nt lds
    buffer_load_dwordx4 v26, s[16:19], s57 offen offset:2048 nt lds
    buffer_load_dwordx4 v27, s[16:19], s57 offen offset:3072 nt lds
    s_waitcnt vmcnt(12)
    s_barrier
    s_movk_i32 s57, 1152
    s_add_u32 m0, s52, 0
    s_nop 0
    buffer_load_dwordx4 v16, s[12:15], s57 offen offset:0 lds
    buffer_load_dwordx4 v17, s[12:15], s57 offen offset:1024 lds
    buffer_load_dwordx4 v18, s[12:15], s57 offen offset:2048 lds
    buffer_load_dwordx4 v19, s[12:15], s57 offen offset:3072 lds
    s_add_u32 m0, s52, 4096
    s_nop 0
    buffer_load_dwordx4 v20, s[12:15], s57 offen offset:0 lds
    buffer_load_dwordx4 v21, s[12:15], s57 offen offset:1024 lds
    buffer_load_dwordx4 v22, s[12:15], s57 offen offset:2048 lds
    buffer_load_dwordx4 v23, s[12:15], s57 offen offset:3072 lds
    s_add_u32 m0, s53, 0
    s_nop 0
    buffer_load_dwordx4 v24, s[16:19], s57 offen offset:0 nt lds
    buffer_load_dwordx4 v25, s[16:19], s57 offen offset:1024 nt lds
    buffer_load_dwordx4 v26, s[16:19], s57 offen offset:2048 nt lds
    buffer_load_dwordx4 v27, s[16:19], s57 offen offset:3072 nt lds
    s_waitcnt vmcnt(12)
    s_barrier
    s_movk_i32 s57, 1280
    s_add_u32 m0, s52, 49152
    s_nop 0
    buffer_load_dwordx4 v16, s[12:15], s57 offen offset:0 lds
    buffer_load_dwordx4 v17, s[12:15], s57 offen offset:1024 lds
    buffer_load_dwordx4 v18, s[12:15], s57 offen offset:2048 lds
    buffer_load_dwordx4 v19, s[12:15], s57 offen offset:3072 lds
    s_add_u32 m0, s52, 53248
    s_nop 0
    buffer_load_dwordx4 v20, s[12:15], s57 offen offset:0 lds
    buffer_load_dwordx4 v21, s[12:15], s57 offen offset:1024 lds
    buffer_load_dwordx4 v22, s[12:15], s57 offen offset:2048 lds
    buffer_load_dwordx4 v23, s[12:15], s57 offen offset:3072 lds
    s_add_u32 m0, s53, 49152
    s_nop 0
    buffer_load_dwordx4 v24, s[16:19], s57 offen offset:0 nt lds
    buffer_load_dwordx4 v25, s[16:19], s57 offen offset:1024 nt lds
    buffer_load_dwordx4 v26, s[16:19], s57 offen offset:2048 nt lds
    buffer_load_dwordx4 v27, s[16:19], s57 offen offset:3072 nt lds
    s_waitcnt vmcnt(12)
    s_barrier
    s_movk_i32 s57, 1408
    s_add_u32 m0, s52, 98304
    s_nop 0
    buffer_load_dwordx4 v16, s[12:15], s57 offen offset:0 lds
    buffer_load_dwordx4 v17, s[12:15], s57 offen offset:1024 lds
    buffer_load_dwordx4 v18, s[12:15], s57 offen offset:2048 lds
    buffer_load_dwordx4 v19, s[12:15], s57 offen offset:3072 lds
    s_add_u32 m0, s52, 102400
    s_nop 0
    buffer_load_dwordx4 v20, s[12:15], s57 offen offset:0 lds
    buffer_load_dwordx4 v21, s[12:15], s57 offen offset:1024 lds
    buffer_load_dwordx4 v22, s[12:15], s57 offen offset:2048 lds
    buffer_load_dwordx4 v23, s[12:15], s57 offen offset:3072 lds
    s_add_u32 m0, s53, 98304
    s_nop 0
    buffer_load_dwordx4 v24, s[16:19], s57 offen offset:0 nt lds
    buffer_load_dwordx4 v25, s[16:19], s57 offen offset:1024 nt lds
    buffer_load_dwordx4 v26, s[16:19], s57 offen offset:2048 nt lds
    buffer_load_dwordx4 v27, s[16:19], s57 offen offset:3072 nt lds
    s_waitcnt vmcnt(12)
    s_barrier
    s_movk_i32 s57, 1536
    s_add_u32 m0, s52, 0
    s_nop 0
    buffer_load_dwordx4 v16, s[12:15], s57 offen offset:0 lds
    buffer_load_dwordx4 v17, s[12:15], s57 offen offset:1024 lds
    buffer_load_dwordx4 v18, s[12:15], s57 offen offset:2048 lds
    buffer_load_dwordx4 v19, s[12:15], s57 offen offset:3072 lds
    s_add_u32 m0, s52, 4096
    s_nop 0
    buffer_load_dwordx4 v20, s[12:15], s57 offen offset:0 lds
    buffer_load_dwordx4 v21, s[12:15], s57 offen offset:1024 lds
    buffer_load_dwordx4 v22, s[12:15], s57 offen offset:2048 lds
    buffer_load_dwordx4 v23, s[12:15], s57 offen offset:3072 lds
    s_add_u32 m0, s53, 0
    s_nop 0
    buffer_load_dwordx4 v24, s[16:19], s57 offen offset:0 nt lds
    buffer_load_dwordx4 v25, s[16:19], s57 offen offset:1024 nt lds
    buffer_load_dwordx4 v26, s[16:19], s57 offen offset:2048 nt lds
    buffer_load_dwordx4 v27, s[16:19], s57 offen offset:3072 nt lds
    s_waitcnt vmcnt(12)
    s_barrier
    s_movk_i32 s57, 1664
    s_add_u32 m0, s52, 49152
    s_nop 0
    buffer_load_dwordx4 v16, s[12:15], s57 offen offset:0 lds
    buffer_load_dwordx4 v17, s[12:15], s57 offen offset:1024 lds
    buffer_load_dwordx4 v18, s[12:15], s57 offen offset:2048 lds
    buffer_load_dwordx4 v19, s[12:15], s57 offen offset:3072 lds
    s_add_u32 m0, s52, 53248
    s_nop 0
    buffer_load_dwordx4 v20, s[12:15], s57 offen offset:0 lds
    buffer_load_dwordx4 v21, s[12:15], s57 offen offset:1024 lds
    buffer_load_dwordx4 v22, s[12:15], s57 offen offset:2048 lds
    buffer_load_dwordx4 v23, s[12:15], s57 offen offset:3072 lds
    s_add_u32 m0, s53, 49152
    s_nop 0
    buffer_load_dwordx4 v24, s[16:19], s57 offen offset:0 nt lds
    buffer_load_dwordx4 v25, s[16:19], s57 offen offset:1024 nt lds
    buffer_load_dwordx4 v26, s[16:19], s57 offen offset:2048 nt lds
    buffer_load_dwordx4 v27, s[16:19], s57 offen offset:3072 nt lds
    v_and_b32 v40, 31, v0
    v_lshlrev_b32 v41, 2, v40
    buffer_load_dword v42, v41, s[24:27], 0 offen sc1
    s_waitcnt vmcnt(13)
    s_barrier
    s_movk_i32 s57, 1792
    s_add_u32 m0, s52, 98304
    s_nop 0
    buffer_load_dwordx4 v16, s[12:15], s57 offen offset:0 lds
    buffer_load_dwordx4 v17, s[12:15], s57 offen offset:1024 lds
    buffer_load_dwordx4 v18, s[12:15], s57 offen offset:2048 lds
    buffer_load_dwordx4 v19, s[12:15], s57 offen offset:3072 lds
    s_add_u32 m0, s52, 102400
    s_nop 0
    buffer_load_dwordx4 v20, s[12:15], s57 offen offset:0 lds
    buffer_load_dwordx4 v21, s[12:15], s57 offen offset:1024 lds
    buffer_load_dwordx4 v22, s[12:15], s57 offen offset:2048 lds
    buffer_load_dwordx4 v23, s[12:15], s57 offen offset:3072 lds
    s_add_u32 m0, s53, 98304
    s_nop 0
    buffer_load_dwordx4 v24, s[16:19], s57 offen offset:0 nt lds
    buffer_load_dwordx4 v25, s[16:19], s57 offen offset:1024 nt lds
    buffer_load_dwordx4 v26, s[16:19], s57 offen offset:2048 nt lds
    buffer_load_dwordx4 v27, s[16:19], s57 offen offset:3072 nt lds
    s_mov_b32 s51, L_code_end-gated_mix__ssm_conv_s5__ssm_conv_s5__prompt_kernel-4
    s_lshl_b32 s50, s46, 13
    v_lshlrev_b32 v60, 7, v0
    v_add_u32 v60, s50, v60
    v_min_u32 v61, s51, v60
    v_and_b32 v61, -4, v61
    global_load_dword v9, v61, s[100:101]
    s_waitcnt vmcnt(14)
    s_barrier
    s_movk_i32 s57, 1920
    s_add_u32 m0, s52, 0
    s_nop 0
    buffer_load_dwordx4 v16, s[12:15], s57 offen offset:0 lds
    buffer_load_dwordx4 v17, s[12:15], s57 offen offset:1024 lds
    buffer_load_dwordx4 v18, s[12:15], s57 offen offset:2048 lds
    buffer_load_dwordx4 v19, s[12:15], s57 offen offset:3072 lds
    s_add_u32 m0, s52, 4096
    s_nop 0
    buffer_load_dwordx4 v20, s[12:15], s57 offen offset:0 lds
    buffer_load_dwordx4 v21, s[12:15], s57 offen offset:1024 lds
    buffer_load_dwordx4 v22, s[12:15], s57 offen offset:2048 lds
    buffer_load_dwordx4 v23, s[12:15], s57 offen offset:3072 lds
    s_add_u32 m0, s53, 0
    s_nop 0
    buffer_load_dwordx4 v24, s[16:19], s57 offen offset:0 nt lds
    buffer_load_dwordx4 v25, s[16:19], s57 offen offset:1024 nt lds
    buffer_load_dwordx4 v26, s[16:19], s57 offen offset:2048 nt lds
    buffer_load_dwordx4 v27, s[16:19], s57 offen offset:3072 nt lds
    s_waitcnt vmcnt(25)
    s_lshr_b32 s50, s2, 6
    s_mov_b32 s72, s80
    s_mov_b32 s73, s81
    s_cmp_eq_u32 s50, 1
    s_cselect_b32 s72, s82, s72
    s_cselect_b32 s73, s83, s73
    s_cmp_eq_u32 s50, 2
    s_cselect_b32 s72, s84, s72
    s_cselect_b32 s73, s85, s73
    s_cmp_eq_u32 s50, 3
    s_cselect_b32 s72, s86, s72
    s_cselect_b32 s73, s87, s73
    s_mov_b32 s74, 0x200000
    s_mov_b32 s75, 0x00020000
    s_and_b32 s66, s2, 63
    s_lshl_b32 s66, s66, 15
    s_lshl_b32 s51, s46, 13
    s_add_u32 s66, s66, s51
    v_lshlrev_b32 v45, 7, v0
    buffer_load_dword v9, v45, s[72:75], s66 offen
    s_bfe_u32 s60, s2, 0x20001
    s_lshl_b32 s60, s60, 2
    s_bfe_u32 s62, s2, 0x20003
    s_add_u32 s60, s60, s62
    s_lshl_b32 s60, s60, 7
    s_and_b32 s62, s2, 1
    s_lshl_b32 s62, s62, 3
    s_lshr_b32 s63, s2, 5
    s_add_u32 s62, s62, s63
    s_lshl_b32 s62, s62, 6
    s_cmp_lg_u32 s46, 0
    s_cbranch_scc1 L_clr_ok
    s_lshl_b32 s48, 1, s40
    s_sub_u32 s48, s48, 1
    s_lshr_b32 s49, s60, 8
    s_lshl_b32 s49, 1, s49
    v_mov_b32 v43, s49
    v_mov_b32 v44, s48
    v_cmp_eq_u32 vcc, s41, v40
    s_nop 1
    v_cndmask_b32 v44, 0, v44, vcc
    v_or_b32 v43, v43, v44
    s_mov_b32 s50, 131072
L_clr_poll:
    v_and_b32 v42, v42, v43
    v_cmp_ne_u32 vcc, v42, v43
    s_cbranch_vccz L_clr_ok
    s_sub_u32 s50, s50, 1
    s_cmp_eq_u32 s50, 0
    s_cbranch_scc1 L_clr_ok
    s_sleep 2
    buffer_load_dword v42, v41, s[24:27], 0 offen sc1
    s_waitcnt vmcnt(0)
    s_branch L_clr_poll
L_clr_ok:
    s_lshr_b32 s47, s46, 1
    s_and_b32 s48, s46, 1
    s_cmp_eq_u32 s47, 0
    s_cselect_b32 s8, s80, s84
    s_cselect_b32 s9, s81, s85
    s_cselect_b32 s10, s82, s86
    s_cselect_b32 s11, s83, s87
    s_mov_b32 s16, s8
    s_mov_b32 s17, s9
    s_mov_b32 s18, 0x200000
    s_mov_b32 s19, 0x00020000
    s_lshl_b32 s49, s48, 5
    s_add_u32 s49, s49, s62
    v_add_u32 v7, s49, v1
    v_lshlrev_b32 v7, 11, v7
    v_add_u32 v12, v7, v4
    v_add_u32 v13, v7, v5
    v_add_u32 v14, 32768, v12
    v_add_u32 v15, 32768, v13
    v_add_u32 v13, 16384, v13
    v_add_u32 v15, 16384, v15
    v_add_u32 v28, 0, v12
    v_add_u32 v29, 4294966272, v13
    v_add_u32 v30, 4294965248, v14
    v_add_u32 v31, 4294964224, v15
    s_lshl_b32 s53, s47, 13
    s_lshl_b32 s49, s48, 12
    s_add_u32 s53, s53, s49
    s_waitcnt vmcnt(14)
    s_barrier
    s_lshl_b32 s50, s46, 5
    s_add_u32 s50, s50, s60
    s_lshl_b32 s50, s50, 11
    s_lshl_b32 s51, s62, 1
    s_add_u32 s50, s50, s51
    v_lshrrev_b32 v24, 3, v0
    v_lshlrev_b32 v24, 11, v24
    v_and_b32 v25, 7, v0
    v_lshlrev_b32 v25, 4, v25
    v_add_u32 v24, v24, v25
    s_cmp_lt_u32 s46, 2
    s_cselect_b32 s51, 155648, s96
    s_and_b32 s54, s46, 1
    s_lshl_b32 s54, s54, 12
    s_add_u32 s51, s51, s54
    s_add_u32 m0, s51, 0
    s_add_u32 s54, s50, 0
    buffer_load_dwordx4 v24, s[12:15], s54 offen lds
    s_add_u32 m0, s51, 1024
    s_add_u32 s54, s50, 16384
    buffer_load_dwordx4 v24, s[12:15], s54 offen lds
    s_add_u32 m0, s51, 2048
    s_add_u32 s54, s50, 32768
    buffer_load_dwordx4 v24, s[12:15], s54 offen lds
    s_add_u32 m0, s51, 3072
    s_add_u32 s54, s50, 49152
    buffer_load_dwordx4 v24, s[12:15], s54 offen lds
    s_cmp_lt_u32 s46, 2
    s_cbranch_scc0 L_noxt
    s_cmp_eq_u32 s46, 0
    s_cselect_b32 s72, s90, s92
    s_cselect_b32 s73, s91, s93
    s_mov_b32 s74, 2048
    s_mov_b32 s75, 0x00020000
    s_lshl_b32 s51, s62, 1
    v_lshlrev_b32 v25, 2, v0
    s_lshl_b32 s54, s46, 7
    s_add_u32 m0, s54, 75776
    s_mov_b32 exec_hi, 0
    buffer_load_dword v25, s[72:75], s51 offen lds
    s_mov_b64 exec, -1
L_noxt:
    s_mov_b32 s72, s34
    s_mov_b32 s73, s35
    s_mov_b32 s74, 2048
    s_mov_b32 s75, 0x00020000
    s_lshl_b32 s50, s40, 8
    s_lshl_b32 s51, s41, 3
    s_add_u32 s50, s50, s51
    s_lshl_b32 s51, s46, 1
    s_add_u32 s67, s50, s51
    s_lshl_b32 s50, s67, 11
    v_lshlrev_b32 v27, 4, v0
    buffer_load_dwordx4 v[32:35], v27, s[72:75], 0 offen
    buffer_load_dwordx4 v[36:39], v27, s[72:75], 0 offen offset:1024
    s_add_u32 s51, s50, 0
    buffer_load_dwordx4 v[40:43], v27, s[12:15], s51 offen
    buffer_load_dwordx4 v[44:47], v27, s[12:15], s51 offen offset:1024
    s_add_u32 s51, s50, 2048
    buffer_load_dwordx4 v[48:51], v27, s[12:15], s51 offen
    buffer_load_dwordx4 v[52:55], v27, s[12:15], s51 offen offset:1024
    s_waitcnt vmcnt(11)
    s_barrier
    s_mov_b32 s16, s8
    s_mov_b32 s17, s9
    s_add_u32 m0, s53, 81920
    s_movk_i32 s56, 0
    buffer_load_dwordx4 v28, s[16:19], s56 offen offset:0 lds
    buffer_load_dwordx4 v29, s[16:19], s56 offen offset:1024 lds
    buffer_load_dwordx4 v30, s[16:19], s56 offen offset:2048 lds
    buffer_load_dwordx4 v31, s[16:19], s56 offen offset:3072 lds
    s_add_u32 m0, s53, 98304
    s_movk_i32 s56, 128
    buffer_load_dwordx4 v28, s[16:19], s56 offen offset:0 lds
    buffer_load_dwordx4 v29, s[16:19], s56 offen offset:1024 lds
    buffer_load_dwordx4 v30, s[16:19], s56 offen offset:2048 lds
    buffer_load_dwordx4 v31, s[16:19], s56 offen offset:3072 lds
    s_add_u32 m0, s53, 114688
    s_movk_i32 s56, 256
    buffer_load_dwordx4 v28, s[16:19], s56 offen offset:0 lds
    buffer_load_dwordx4 v29, s[16:19], s56 offen offset:1024 lds
    buffer_load_dwordx4 v30, s[16:19], s56 offen offset:2048 lds
    buffer_load_dwordx4 v31, s[16:19], s56 offen offset:3072 lds
    s_add_u32 m0, s53, 131072
    s_movk_i32 s56, 384
    buffer_load_dwordx4 v28, s[16:19], s56 offen offset:0 lds
    buffer_load_dwordx4 v29, s[16:19], s56 offen offset:1024 lds
    buffer_load_dwordx4 v30, s[16:19], s56 offen offset:2048 lds
    buffer_load_dwordx4 v31, s[16:19], s56 offen offset:3072 lds
    s_barrier
    s_movk_i32 s57, 1280
    buffer_load_dwordx4 v[96:99], v12, s[16:19], s57 offen
    s_movk_i32 s57, 1280
    buffer_load_dwordx4 v[100:103], v13, s[16:19], s57 offen
    s_movk_i32 s57, 1280
    buffer_load_dwordx4 v[104:107], v14, s[16:19], s57 offen
    s_movk_i32 s57, 1280
    buffer_load_dwordx4 v[108:111], v15, s[16:19], s57 offen
    s_movk_i32 s57, 1408
    buffer_load_dwordx4 v[112:115], v12, s[16:19], s57 offen
    s_movk_i32 s57, 1408
    buffer_load_dwordx4 v[116:119], v13, s[16:19], s57 offen
    s_movk_i32 s57, 1408
    buffer_load_dwordx4 v[120:123], v14, s[16:19], s57 offen
    s_movk_i32 s57, 1408
    buffer_load_dwordx4 v[124:127], v15, s[16:19], s57 offen
    s_movk_i32 s57, 1536
    buffer_load_dwordx4 v[128:131], v12, s[16:19], s57 offen
    s_movk_i32 s57, 1536
    buffer_load_dwordx4 v[132:135], v13, s[16:19], s57 offen
    s_movk_i32 s57, 1536
    buffer_load_dwordx4 v[136:139], v14, s[16:19], s57 offen
    s_movk_i32 s57, 1536
    buffer_load_dwordx4 v[140:143], v15, s[16:19], s57 offen
    s_movk_i32 s57, 1664
    buffer_load_dwordx4 v[144:147], v12, s[16:19], s57 offen
    s_movk_i32 s57, 1664
    buffer_load_dwordx4 v[148:151], v13, s[16:19], s57 offen
    s_movk_i32 s57, 1664
    buffer_load_dwordx4 v[152:155], v14, s[16:19], s57 offen
    s_movk_i32 s57, 1664
    buffer_load_dwordx4 v[156:159], v15, s[16:19], s57 offen
    s_barrier
    s_waitcnt vmcnt(32)
    v_lshlrev_b32 v56, 16, v32
    v_and_b32 v57, 0xffff0000, v32
    v_lshlrev_b32 v58, 16, v33
    v_and_b32 v59, 0xffff0000, v33
    v_lshlrev_b32 v60, 16, v34
    v_and_b32 v61, 0xffff0000, v34
    v_lshlrev_b32 v62, 16, v35
    v_and_b32 v63, 0xffff0000, v35
    v_lshlrev_b32 v64, 16, v36
    v_and_b32 v65, 0xffff0000, v36
    v_lshlrev_b32 v66, 16, v37
    v_and_b32 v67, 0xffff0000, v37
    v_lshlrev_b32 v68, 16, v38
    v_and_b32 v69, 0xffff0000, v38
    v_lshlrev_b32 v70, 16, v39
    v_and_b32 v71, 0xffff0000, v39
    v_mov_b32 v72, 0
    v_mov_b32 v73, 0
    v_mov_b32 v74, 0
    v_mov_b32 v75, 0
    v_lshlrev_b32 v76, 16, v40
    v_and_b32 v77, 0xffff0000, v40
    v_lshlrev_b32 v80, 16, v48
    v_and_b32 v81, 0xffff0000, v48
    v_pk_mul_f32 v[76:77], v[76:77], v[56:57] op_sel:[0,0] op_sel_hi:[1,1]
    v_pk_mul_f32 v[80:81], v[80:81], v[56:57] op_sel:[0,0] op_sel_hi:[1,1]
    v_cvt_pk_bf16_f32 v78, v76, v77
    v_cvt_pk_bf16_f32 v82, v80, v81
    v_lshlrev_b32 v76, 16, v78
    v_and_b32 v77, 0xffff0000, v78
    v_lshlrev_b32 v80, 16, v82
    v_and_b32 v81, 0xffff0000, v82
    v_pk_add_f32 v[72:73], v[72:73], v[76:77]
    v_pk_add_f32 v[74:75], v[74:75], v[80:81]
    v_lshlrev_b32 v76, 16, v41
    v_and_b32 v77, 0xffff0000, v41
    v_lshlrev_b32 v80, 16, v49
    v_and_b32 v81, 0xffff0000, v49
    v_pk_mul_f32 v[76:77], v[76:77], v[58:59] op_sel:[0,0] op_sel_hi:[1,1]
    v_pk_mul_f32 v[80:81], v[80:81], v[58:59] op_sel:[0,0] op_sel_hi:[1,1]
    v_cvt_pk_bf16_f32 v78, v76, v77
    v_cvt_pk_bf16_f32 v82, v80, v81
    v_lshlrev_b32 v76, 16, v78
    v_and_b32 v77, 0xffff0000, v78
    v_lshlrev_b32 v80, 16, v82
    v_and_b32 v81, 0xffff0000, v82
    v_pk_add_f32 v[72:73], v[72:73], v[76:77]
    v_pk_add_f32 v[74:75], v[74:75], v[80:81]
    v_lshlrev_b32 v76, 16, v42
    v_and_b32 v77, 0xffff0000, v42
    v_lshlrev_b32 v80, 16, v50
    v_and_b32 v81, 0xffff0000, v50
    v_pk_mul_f32 v[76:77], v[76:77], v[60:61] op_sel:[0,0] op_sel_hi:[1,1]
    v_pk_mul_f32 v[80:81], v[80:81], v[60:61] op_sel:[0,0] op_sel_hi:[1,1]
    v_cvt_pk_bf16_f32 v78, v76, v77
    v_cvt_pk_bf16_f32 v82, v80, v81
    v_lshlrev_b32 v76, 16, v78
    v_and_b32 v77, 0xffff0000, v78
    v_lshlrev_b32 v80, 16, v82
    v_and_b32 v81, 0xffff0000, v82
    v_pk_add_f32 v[72:73], v[72:73], v[76:77]
    v_pk_add_f32 v[74:75], v[74:75], v[80:81]
    v_lshlrev_b32 v76, 16, v43
    v_and_b32 v77, 0xffff0000, v43
    v_lshlrev_b32 v80, 16, v51
    v_and_b32 v81, 0xffff0000, v51
    v_pk_mul_f32 v[76:77], v[76:77], v[62:63] op_sel:[0,0] op_sel_hi:[1,1]
    v_pk_mul_f32 v[80:81], v[80:81], v[62:63] op_sel:[0,0] op_sel_hi:[1,1]
    v_cvt_pk_bf16_f32 v78, v76, v77
    v_cvt_pk_bf16_f32 v82, v80, v81
    v_lshlrev_b32 v76, 16, v78
    v_and_b32 v77, 0xffff0000, v78
    v_lshlrev_b32 v80, 16, v82
    v_and_b32 v81, 0xffff0000, v82
    v_pk_add_f32 v[72:73], v[72:73], v[76:77]
    v_pk_add_f32 v[74:75], v[74:75], v[80:81]
    v_lshlrev_b32 v76, 16, v44
    v_and_b32 v77, 0xffff0000, v44
    v_lshlrev_b32 v80, 16, v52
    v_and_b32 v81, 0xffff0000, v52
    v_pk_mul_f32 v[76:77], v[76:77], v[64:65] op_sel:[0,0] op_sel_hi:[1,1]
    v_pk_mul_f32 v[80:81], v[80:81], v[64:65] op_sel:[0,0] op_sel_hi:[1,1]
    v_cvt_pk_bf16_f32 v78, v76, v77
    v_cvt_pk_bf16_f32 v82, v80, v81
    v_lshlrev_b32 v76, 16, v78
    v_and_b32 v77, 0xffff0000, v78
    v_lshlrev_b32 v80, 16, v82
    v_and_b32 v81, 0xffff0000, v82
    v_pk_add_f32 v[72:73], v[72:73], v[76:77]
    v_pk_add_f32 v[74:75], v[74:75], v[80:81]
    v_lshlrev_b32 v76, 16, v45
    v_and_b32 v77, 0xffff0000, v45
    v_lshlrev_b32 v80, 16, v53
    v_and_b32 v81, 0xffff0000, v53
    v_pk_mul_f32 v[76:77], v[76:77], v[66:67] op_sel:[0,0] op_sel_hi:[1,1]
    v_pk_mul_f32 v[80:81], v[80:81], v[66:67] op_sel:[0,0] op_sel_hi:[1,1]
    v_cvt_pk_bf16_f32 v78, v76, v77
    v_cvt_pk_bf16_f32 v82, v80, v81
    v_lshlrev_b32 v76, 16, v78
    v_and_b32 v77, 0xffff0000, v78
    v_lshlrev_b32 v80, 16, v82
    v_and_b32 v81, 0xffff0000, v82
    v_pk_add_f32 v[72:73], v[72:73], v[76:77]
    v_pk_add_f32 v[74:75], v[74:75], v[80:81]
    v_lshlrev_b32 v76, 16, v46
    v_and_b32 v77, 0xffff0000, v46
    v_lshlrev_b32 v80, 16, v54
    v_and_b32 v81, 0xffff0000, v54
    v_pk_mul_f32 v[76:77], v[76:77], v[68:69] op_sel:[0,0] op_sel_hi:[1,1]
    v_pk_mul_f32 v[80:81], v[80:81], v[68:69] op_sel:[0,0] op_sel_hi:[1,1]
    v_cvt_pk_bf16_f32 v78, v76, v77
    v_cvt_pk_bf16_f32 v82, v80, v81
    v_lshlrev_b32 v76, 16, v78
    v_and_b32 v77, 0xffff0000, v78
    v_lshlrev_b32 v80, 16, v82
    v_and_b32 v81, 0xffff0000, v82
    v_pk_add_f32 v[72:73], v[72:73], v[76:77]
    v_pk_add_f32 v[74:75], v[74:75], v[80:81]
    v_lshlrev_b32 v76, 16, v47
    v_and_b32 v77, 0xffff0000, v47
    v_lshlrev_b32 v80, 16, v55
    v_and_b32 v81, 0xffff0000, v55
    v_pk_mul_f32 v[76:77], v[76:77], v[70:71] op_sel:[0,0] op_sel_hi:[1,1]
    v_pk_mul_f32 v[80:81], v[80:81], v[70:71] op_sel:[0,0] op_sel_hi:[1,1]
    v_cvt_pk_bf16_f32 v78, v76, v77
    v_cvt_pk_bf16_f32 v82, v80, v81
    v_lshlrev_b32 v76, 16, v78
    v_and_b32 v77, 0xffff0000, v78
    v_lshlrev_b32 v80, 16, v82
    v_and_b32 v81, 0xffff0000, v82
    v_pk_add_f32 v[72:73], v[72:73], v[76:77]
    v_pk_add_f32 v[74:75], v[74:75], v[80:81]
    v_add_f32 v72, v72, v73
    v_add_f32 v74, v74, v75
    s_nop 0
    v_add_f32_dpp v72, v72, v72 row_shr:1 row_mask:0xf bank_mask:0xf bound_ctrl:0
    v_add_f32_dpp v74, v74, v74 row_shr:1 row_mask:0xf bank_mask:0xf bound_ctrl:0
    s_nop 0
    v_add_f32_dpp v72, v72, v72 row_shr:2 row_mask:0xf bank_mask:0xf bound_ctrl:0
    v_add_f32_dpp v74, v74, v74 row_shr:2 row_mask:0xf bank_mask:0xf bound_ctrl:0
    s_nop 0
    v_add_f32_dpp v72, v72, v72 row_shr:4 row_mask:0xf bank_mask:0xf bound_ctrl:0
    v_add_f32_dpp v74, v74, v74 row_shr:4 row_mask:0xf bank_mask:0xf bound_ctrl:0
    s_nop 0
    v_add_f32_dpp v72, v72, v72 row_shr:8 row_mask:0xf bank_mask:0xf bound_ctrl:0
    v_add_f32_dpp v74, v74, v74 row_shr:8 row_mask:0xf bank_mask:0xf bound_ctrl:0
    s_nop 0
    v_add_f32_dpp v72, v72, v72 row_bcast:15 row_mask:0xa bank_mask:0xf
    v_add_f32_dpp v74, v74, v74 row_bcast:15 row_mask:0xa bank_mask:0xf
    s_nop 0
    v_add_f32_dpp v72, v72, v72 row_bcast:31 row_mask:0xc bank_mask:0xf
    v_add_f32_dpp v74, v74, v74 row_bcast:31 row_mask:0xc bank_mask:0xf
    v_readlane_b32 s54, v72, 63
    v_readlane_b32 s55, v74, 63
    s_nop 0
    v_mov_b32 v84, s54
    s_nop 1
    v_writelane_b32 v84, s55, 1
    v_cvt_pk_bf16_f32 v84, v84, v84
    v_and_b32 v84, 0xffff0000, v84
    v_sub_f32 v85, 0, v84
    s_mov_b32 s72, 0x3fb8aa3b
    s_mov_b32 s73, 0x32a57060
    s_mov_b32 s74, 0x3f317218
    v_mul_f32 v87, s72, v85
    v_fma_f32 v88, v85, s72, -v87
    v_fma_f32 v88, v85, s73, v88
    v_exp_f32 v87, v87
    v_mul_f32 v88, s74, v88
    v_fma_f32 v86, v87, v88, v87
    v_add_f32 v86, 1.0, v86
    v_rcp_f32 v87, v86
    s_nop 0
    v_fma_f32 v88, -v86, v87, 1.0
    v_fma_f32 v87, v88, v87, v87
    v_cvt_pk_bf16_f32 v87, v87, v87
    v_and_b32 v90, 0xffff0000, v87
    v_sub_f32 v88, 1.0, v90
    v_cvt_pk_bf16_f32 v88, v88, v88
    v_and_b32 v91, 0xffff0000, v88
    s_lshl_b32 s54, s67, 3
    s_add_u32 s54, s54, 17039360
    v_lshlrev_b32 v89, 3, v0
    s_mov_b64 exec, 3
    buffer_store_dwordx2 v[90:91], v89, s[20:23], s54 offen sc1
    s_mov_b64 exec, -1
    s_movk_i32 s57, 1792
    buffer_load_dwordx4 v[160:163], v12, s[16:19], s57 offen
    s_movk_i32 s57, 1792
    buffer_load_dwordx4 v[164:167], v13, s[16:19], s57 offen
    s_movk_i32 s57, 1792
    buffer_load_dwordx4 v[168:171], v14, s[16:19], s57 offen
    s_movk_i32 s57, 1792
    buffer_load_dwordx4 v[172:175], v15, s[16:19], s57 offen
    s_movk_i32 s57, 1920
    buffer_load_dwordx4 v[176:179], v12, s[16:19], s57 offen
    s_movk_i32 s57, 1920
    buffer_load_dwordx4 v[180:183], v13, s[16:19], s57 offen
    s_movk_i32 s57, 1920
    buffer_load_dwordx4 v[184:187], v14, s[16:19], s57 offen
    s_movk_i32 s57, 1920
    buffer_load_dwordx4 v[188:191], v15, s[16:19], s57 offen
    s_mov_b32 s16, s10
    s_mov_b32 s17, s11
    s_movk_i32 s57, 0
    buffer_load_dwordx4 v[192:195], v12, s[16:19], s57 offen
    s_movk_i32 s57, 0
    buffer_load_dwordx4 v[196:199], v13, s[16:19], s57 offen
    s_movk_i32 s57, 0
    buffer_load_dwordx4 v[200:203], v14, s[16:19], s57 offen
    s_movk_i32 s57, 0
    buffer_load_dwordx4 v[204:207], v15, s[16:19], s57 offen
    s_lshl_b32 s55, s46, 2
    v_bfe_u32 v1, v0, 2, 2
    s_mov_b32 s49, 528
    v_mul_lo_u32 v1, v1, s49
    v_lshrrev_b32 v2, 4, v0
    v_lshlrev_b32 v2, 5, v2
    v_add_u32 v1, v1, v2
    v_and_b32 v2, 3, v0
    v_lshlrev_b32 v2, 3, v2
    v_add_u32 v1, v1, v2
    s_mul_i32 s48, s55, 4224
    v_add_u32 v1, s48, v1
    s_lshl_b32 s48, s42, 8
    s_lshr_b32 s49, s55, 3
    s_lshl_b32 s49, s49, 7
    s_add_u32 s48, s48, s49
    s_lshr_b32 s49, s43, 3
    s_add_u32 s48, s48, s49
    s_and_b32 s49, s55, 7
    s_add_u32 s48, s48, s49
    s_lshl_b32 s48, s48, 11
    s_lshl_b32 s49, s40, 21
    s_add_u32 s48, s48, s49
    v_lshlrev_b32 v2, 4, v0
    s_mov_b32 s98, s55
    s_barrier
    ds_read_b64_tr_b16 v[32:33], v1 offset:0
    ds_read_b64_tr_b16 v[34:35], v1 offset:2112
    ds_read_b64_tr_b16 v[36:37], v1 offset:128
    ds_read_b64_tr_b16 v[38:39], v1 offset:2240
    ds_read_b64_tr_b16 v[40:41], v1 offset:256
    ds_read_b64_tr_b16 v[42:43], v1 offset:2368
    ds_read_b64_tr_b16 v[44:45], v1 offset:384
    ds_read_b64_tr_b16 v[46:47], v1 offset:2496
    ds_read_b64_tr_b16 v[48:49], v1 offset:4224
    ds_read_b64_tr_b16 v[50:51], v1 offset:6336
    ds_read_b64_tr_b16 v[52:53], v1 offset:4352
    ds_read_b64_tr_b16 v[54:55], v1 offset:6464
    ds_read_b64_tr_b16 v[56:57], v1 offset:4480
    ds_read_b64_tr_b16 v[58:59], v1 offset:6592
    ds_read_b64_tr_b16 v[60:61], v1 offset:4608
    ds_read_b64_tr_b16 v[62:63], v1 offset:6720
    s_add_u32 s54, s98, 0
    s_and_b32 s54, s54, 3
    s_lshl_b32 s99, s42, 1
    s_and_b32 s54, s99, 3
    s_lshl_b32 s54, s54, 8
    v_xor_b32 v5, s54, v2
    s_lshr_b32 s99, s99, 2
    s_lshl_b32 s99, s99, 10
    s_xor_b32 s49, s99, 0
    s_add_u32 s49, s49, s48
    s_add_u32 s49, s49, 0
    s_waitcnt lgkmcnt(14)
    buffer_store_dwordx4 v[32:35], v5, s[20:23], s49 offen sc1
    s_xor_b32 s49, s99, 1024
    s_add_u32 s49, s49, s48
    s_add_u32 s49, s49, 0
    s_waitcnt lgkmcnt(12)
    buffer_store_dwordx4 v[36:39], v5, s[20:23], s49 offen sc1
    s_xor_b32 s49, s99, 0
    s_add_u32 s49, s49, s48
    s_add_u32 s49, s49, 1048576
    s_waitcnt lgkmcnt(10)
    buffer_store_dwordx4 v[40:43], v5, s[20:23], s49 offen sc1
    s_xor_b32 s49, s99, 1024
    s_add_u32 s49, s49, s48
    s_add_u32 s49, s49, 1048576
    s_waitcnt lgkmcnt(8)
    buffer_store_dwordx4 v[44:47], v5, s[20:23], s49 offen sc1
    s_barrier
    s_add_u32 s54, s98, 1
    s_and_b32 s54, s54, 3
    s_lshl_b32 s99, s42, 1
    s_and_b32 s54, s99, 3
    s_lshl_b32 s54, s54, 8
    v_xor_b32 v5, s54, v2
    s_lshr_b32 s99, s99, 2
    s_lshl_b32 s99, s99, 10
    s_xor_b32 s49, s99, 0
    s_add_u32 s49, s49, s48
    s_add_u32 s49, s49, 2048
    s_waitcnt lgkmcnt(6)
    buffer_store_dwordx4 v[48:51], v5, s[20:23], s49 offen sc1
    s_xor_b32 s49, s99, 1024
    s_add_u32 s49, s49, s48
    s_add_u32 s49, s49, 2048
    s_waitcnt lgkmcnt(4)
    buffer_store_dwordx4 v[52:55], v5, s[20:23], s49 offen sc1
    s_xor_b32 s49, s99, 0
    s_add_u32 s49, s49, s48
    s_add_u32 s49, s49, 1050624
    s_waitcnt lgkmcnt(2)
    buffer_store_dwordx4 v[56:59], v5, s[20:23], s49 offen sc1
    s_xor_b32 s49, s99, 1024
    s_add_u32 s49, s49, s48
    s_add_u32 s49, s49, 1050624
    s_waitcnt lgkmcnt(0)
    buffer_store_dwordx4 v[60:63], v5, s[20:23], s49 offen sc1
    s_branch L_final
L_compute:
    s_mov_b32 s3, 0
    s_setprio 1
    s_lshr_b32 s46, s45, 1
    s_and_b32 s47, s45, 1
    s_cmp_lg_u32 s45, 1
    s_cbranch_scc1 L_nopl
    s_mov_b32 s68, s28
    s_mov_b32 s69, s29
    s_mov_b32 s70, 0x800
    s_mov_b32 s71, 0x00020000
    s_mov_b32 s72, s30
    s_mov_b32 s73, s31
    s_mov_b32 s74, 0x800
    s_mov_b32 s75, 0x00020000
    v_add_u32 v14, s43, v0
    v_lshlrev_b32 v14, 1, v14
    buffer_load_ushort v16, v14, s[68:71], 0 offen
    buffer_load_ushort v17, v14, s[72:75], 0 offen
    s_mov_b32 s68, s32
    s_mov_b32 s69, s33
    s_mov_b32 s70, 0x800
    s_mov_b32 s71, 0x00020000
    buffer_load_ushort v18, v14, s[68:71], 0 offen
L_nopl:
    s_lshl_b32 s48, s46, 14
    s_lshl_b32 s49, s47, 13
    s_add_u32 s49, s49, 32768
    v_and_b32 v1, 15, v0
    v_lshlrev_b32 v1, 7, v1
    v_lshrrev_b32 v2, 4, v0
    v_bfe_u32 v3, v0, 1, 3
    v_add_u32 v4, 0, v2
    v_xor_b32 v4, v4, v3
    v_lshlrev_b32 v4, 4, v4
    v_add_u32 v4, v4, v1
    v_add_u32 v20, s48, v4
    v_add_u32 v24, s49, v4
    v_add_u32 v4, 4, v2
    v_xor_b32 v4, v4, v3
    v_lshlrev_b32 v4, 4, v4
    v_add_u32 v4, v4, v1
    v_add_u32 v21, s48, v4
    v_add_u32 v25, s49, v4
    v_mov_b32 v128, 0
    v_mov_b32 v129, 0
    v_mov_b32 v130, 0
    v_mov_b32 v131, 0
    v_mov_b32 v132, 0
    v_mov_b32 v133, 0
    v_mov_b32 v134, 0
    v_mov_b32 v135, 0
    v_mov_b32 v136, 0
    v_mov_b32 v137, 0
    v_mov_b32 v138, 0
    v_mov_b32 v139, 0
    v_mov_b32 v140, 0
    v_mov_b32 v141, 0
    v_mov_b32 v142, 0
    v_mov_b32 v143, 0
    v_mov_b32 v144, 0
    v_mov_b32 v145, 0
    v_mov_b32 v146, 0
    v_mov_b32 v147, 0
    v_mov_b32 v148, 0
    v_mov_b32 v149, 0
    v_mov_b32 v150, 0
    v_mov_b32 v151, 0
    v_mov_b32 v152, 0
    v_mov_b32 v153, 0
    v_mov_b32 v154, 0
    v_mov_b32 v155, 0
    v_mov_b32 v156, 0
    v_mov_b32 v157, 0
    v_mov_b32 v158, 0
    v_mov_b32 v159, 0
    v_mov_b32 v160, 0
    v_mov_b32 v161, 0
    v_mov_b32 v162, 0
    v_mov_b32 v163, 0
    v_mov_b32 v164, 0
    v_mov_b32 v165, 0
    v_mov_b32 v166, 0
    v_mov_b32 v167, 0
    v_mov_b32 v168, 0
    v_mov_b32 v169, 0
    v_mov_b32 v170, 0
    v_mov_b32 v171, 0
    v_mov_b32 v172, 0
    v_mov_b32 v173, 0
    v_mov_b32 v174, 0
    v_mov_b32 v175, 0
    v_mov_b32 v176, 0
    v_mov_b32 v177, 0
    v_mov_b32 v178, 0
    v_mov_b32 v179, 0
    v_mov_b32 v180, 0
    v_mov_b32 v181, 0
    v_mov_b32 v182, 0
    v_mov_b32 v183, 0
    v_mov_b32 v184, 0
    v_mov_b32 v185, 0
    v_mov_b32 v186, 0
    v_mov_b32 v187, 0
    v_mov_b32 v188, 0
    v_mov_b32 v189, 0
    v_mov_b32 v190, 0
    v_mov_b32 v191, 0
    v_mov_b32 v192, 0
    v_mov_b32 v193, 0
    v_mov_b32 v194, 0
    v_mov_b32 v195, 0
    v_mov_b32 v196, 0
    v_mov_b32 v197, 0
    v_mov_b32 v198, 0
    v_mov_b32 v199, 0
    v_mov_b32 v200, 0
    v_mov_b32 v201, 0
    v_mov_b32 v202, 0
    v_mov_b32 v203, 0
    v_mov_b32 v204, 0
    v_mov_b32 v205, 0
    v_mov_b32 v206, 0
    v_mov_b32 v207, 0
    v_mov_b32 v208, 0
    v_mov_b32 v209, 0
    v_mov_b32 v210, 0
    v_mov_b32 v211, 0
    v_mov_b32 v212, 0
    v_mov_b32 v213, 0
    v_mov_b32 v214, 0
    v_mov_b32 v215, 0
    v_mov_b32 v216, 0
    v_mov_b32 v217, 0
    v_mov_b32 v218, 0
    v_mov_b32 v219, 0
    v_mov_b32 v220, 0
    v_mov_b32 v221, 0
    v_mov_b32 v222, 0
    v_mov_b32 v223, 0
    v_mov_b32 v224, 0
    v_mov_b32 v225, 0
    v_mov_b32 v226, 0
    v_mov_b32 v227, 0
    v_mov_b32 v228, 0
    v_mov_b32 v229, 0
    v_mov_b32 v230, 0
    v_mov_b32 v231, 0
    v_mov_b32 v232, 0
    v_mov_b32 v233, 0
    v_mov_b32 v234, 0
    v_mov_b32 v235, 0
    v_mov_b32 v236, 0
    v_mov_b32 v237, 0
    v_mov_b32 v238, 0
    v_mov_b32 v239, 0
    v_mov_b32 v240, 0
    v_mov_b32 v241, 0
    v_mov_b32 v242, 0
    v_mov_b32 v243, 0
    v_mov_b32 v244, 0
    v_mov_b32 v245, 0
    v_mov_b32 v246, 0
    v_mov_b32 v247, 0
    v_mov_b32 v248, 0
    v_mov_b32 v249, 0
    v_mov_b32 v250, 0
    v_mov_b32 v251, 0
    v_mov_b32 v252, 0
    v_mov_b32 v253, 0
    v_mov_b32 v254, 0
    v_mov_b32 v255, 0
    s_cmp_lg_u32 s45, 1
    s_cbranch_scc1 L_noparam
    s_waitcnt vmcnt(0)
    v_lshlrev_b32 v16, 16, v16
    v_lshlrev_b32 v17, 16, v17
    v_lshlrev_b32 v18, 16, v18
    s_mov_b32 s60, 0x3fb8aa3b
    s_mov_b32 s61, 0x32a57060
    s_mov_b32 s62, 0x3f317218
    v_mul_f32 v40, s60, v18
    v_fma_f32 v41, v18, s60, -v40
    v_fma_f32 v41, v18, s61, v41
    v_exp_f32 v40, v40
    v_mul_f32 v41, s62, v41
    v_fma_f32 v19, v40, v41, v40
    v_cvt_pk_bf16_f32 v19, v19, v19
    v_and_b32 v19, 0xffff0000, v19
    v_mul_f32 v42, v19, v16
    v_mul_f32 v43, v19, v17
    s_mov_b32 s60, 0x3fb8aa3b
    s_mov_b32 s61, 0x32a57060
    s_mov_b32 s62, 0x3f317218
    v_mul_f32 v40, s60, v42
    v_fma_f32 v41, v42, s60, -v40
    v_fma_f32 v41, v42, s61, v41
    v_exp_f32 v40, v40
    v_mul_f32 v41, s62, v41
    v_fma_f32 v44, v40, v41, v40
    s_mov_b32 s60, 0x3e22f983
    s_mov_b32 s61, 0x31dc9c88
    v_mul_f32 v40, s60, v43
    v_rndne_f32 v40, v40
    v_fma_f32 v41, v43, s60, -v40
    v_fma_f32 v41, v43, s61, v41
    v_cos_f32 v45, v41
    v_sin_f32 v46, v41
    v_mul_f32 v48, v44, v45
    v_mul_f32 v49, v44, v46
    v_add_f32 v40, -1.0, v48
    v_mul_f32 v41, v16, v16
    v_fma_f32 v41, v17, v17, v41
    v_rcp_f32 v47, v41
    s_nop 0
    v_fma_f32 v45, -v41, v47, 1.0
    v_fma_f32 v47, v45, v47, v47
    v_add_f32 v47, v47, v47
    v_mul_f32 v50, v40, v16
    v_fma_f32 v50, v49, v17, v50
    v_mul_f32 v50, v50, v47
    v_mul_f32 v51, v49, v16
    v_fma_f32 v51, -v40, v17, v51
    v_mul_f32 v51, v51, v47
    v_mov_b32 v52, v48
    v_mov_b32 v53, v49
    v_mul_f32 v40, v53, v53
    v_mul_f32 v41, v52, v53
    v_fma_f32 v52, v52, v52, -v40
    v_add_f32 v53, v41, v41
    v_mul_f32 v40, v53, v53
    v_mul_f32 v41, v52, v53
    v_fma_f32 v52, v52, v52, -v40
    v_add_f32 v53, v41, v41
    v_mul_f32 v40, v53, v53
    v_mul_f32 v41, v52, v53
    v_fma_f32 v52, v52, v52, -v40
    v_add_f32 v53, v41, v41
    v_mul_f32 v40, v53, v53
    v_mul_f32 v41, v52, v53
    v_fma_f32 v52, v52, v52, -v40
    v_add_f32 v53, v41, v41
    v_mov_b32 v54, v52
    v_mov_b32 v55, v53
    v_mul_f32 v40, v53, v53
    v_mul_f32 v41, v52, v53
    v_fma_f32 v52, v52, v52, -v40
    v_add_f32 v53, v41, v41
    v_mov_b32 v56, v52
    v_mov_b32 v57, v53
    v_mul_f32 v40, v53, v53
    v_mul_f32 v41, v52, v53
    v_fma_f32 v52, v52, v52, -v40
    v_add_f32 v53, v41, v41
    v_mul_f32 v40, v53, v53
    v_mul_f32 v41, v52, v53
    v_fma_f32 v52, v52, v52, -v40
    v_add_f32 v53, v41, v41
    v_mul_f32 v40, v53, v53
    v_mul_f32 v41, v52, v53
    v_fma_f32 v52, v52, v52, -v40
    v_add_f32 v53, v41, v41
    v_mov_b32 v58, v52
    v_mov_b32 v59, v53
    v_lshrrev_b32 v40, 5, v0
    v_lshlrev_b32 v40, 7, v40
    v_and_b32 v41, 15, v0
    v_lshlrev_b32 v41, 3, v41
    v_add_u32 v40, v40, v41
    v_bfe_u32 v41, v0, 4, 1
    v_lshlrev_b32 v41, 2, v41
    v_add_u32 v40, v40, v41
    v_add_u32 v40, 147456, v40
    ds_write_b32 v40, v48 offset:0
    ds_write_b32 v40, v49 offset:256
    ds_write_b32 v40, v50 offset:512
    ds_write_b32 v40, v51 offset:768
    ds_write_b32 v40, v54 offset:1024
    ds_write_b32 v40, v55 offset:1280
    ds_write_b32 v40, v56 offset:1536
    ds_write_b32 v40, v57 offset:1792
    ds_write_b32 v40, v58 offset:2048
    ds_write_b32 v40, v59 offset:2304
    s_waitcnt lgkmcnt(0)
L_noparam:
    s_barrier
    ds_read_b128 v[32:35], v20 offset:0
    ds_read_b128 v[64:67], v24 offset:0
    ds_read_b128 v[68:71], v24 offset:2048
    ds_read_b128 v[72:75], v24 offset:4096
    ds_read_b128 v[76:79], v24 offset:6144
    ds_read_b128 v[36:39], v20 offset:2048
    ds_read_b128 v[40:43], v20 offset:4096
    ds_read_b128 v[44:47], v20 offset:6144
    ds_read_b128 v[48:51], v20 offset:8192
    ds_read_b128 v[52:55], v20 offset:10240
    ds_read_b128 v[56:59], v20 offset:12288
    ds_read_b128 v[60:63], v20 offset:14336
    s_mov_b32 s58, 16
    s_mov_b32 s59, 0
    s_mov_b32 s61, 4294868992
    s_mov_b32 s66, 49152
L_cA_loop:
    s_waitcnt lgkmcnt(0)
    v_mfma_f32_16x16x32_bf16 v[128:131], v[32:35], v[64:67], v[128:131]
    ds_read_b128 v[80:83], v21 offset:0
    v_mfma_f32_16x16x32_bf16 v[132:135], v[32:35], v[68:71], v[132:135]
    v_mfma_f32_16x16x32_bf16 v[136:139], v[32:35], v[72:75], v[136:139]
    ds_read_b128 v[112:115], v25 offset:0
    v_mfma_f32_16x16x32_bf16 v[140:143], v[32:35], v[76:79], v[140:143]
    v_mfma_f32_16x16x32_bf16 v[156:159], v[36:39], v[76:79], v[156:159]
    ds_read_b128 v[116:119], v25 offset:2048
    v_mfma_f32_16x16x32_bf16 v[152:155], v[36:39], v[72:75], v[152:155]
    v_mfma_f32_16x16x32_bf16 v[148:151], v[36:39], v[68:71], v[148:151]
    ds_read_b128 v[120:123], v25 offset:4096
    v_mfma_f32_16x16x32_bf16 v[144:147], v[36:39], v[64:67], v[144:147]
    v_mfma_f32_16x16x32_bf16 v[160:163], v[40:43], v[64:67], v[160:163]
    ds_read_b128 v[124:127], v25 offset:6144
    v_mfma_f32_16x16x32_bf16 v[164:167], v[40:43], v[68:71], v[164:167]
    v_mfma_f32_16x16x32_bf16 v[168:171], v[40:43], v[72:75], v[168:171]
    ds_read_b128 v[84:87], v21 offset:2048
    v_mfma_f32_16x16x32_bf16 v[172:175], v[40:43], v[76:79], v[172:175]
    v_mfma_f32_16x16x32_bf16 v[188:191], v[44:47], v[76:79], v[188:191]
    ds_read_b128 v[88:91], v21 offset:4096
    v_mfma_f32_16x16x32_bf16 v[184:187], v[44:47], v[72:75], v[184:187]
    v_mfma_f32_16x16x32_bf16 v[180:183], v[44:47], v[68:71], v[180:183]
    ds_read_b128 v[92:95], v21 offset:6144
    v_mfma_f32_16x16x32_bf16 v[176:179], v[44:47], v[64:67], v[176:179]
    v_mfma_f32_16x16x32_bf16 v[192:195], v[48:51], v[64:67], v[192:195]
    ds_read_b128 v[96:99], v21 offset:8192
    v_mfma_f32_16x16x32_bf16 v[196:199], v[48:51], v[68:71], v[196:199]
    v_mfma_f32_16x16x32_bf16 v[200:203], v[48:51], v[72:75], v[200:203]
    ds_read_b128 v[100:103], v21 offset:10240
    v_mfma_f32_16x16x32_bf16 v[204:207], v[48:51], v[76:79], v[204:207]
    v_mfma_f32_16x16x32_bf16 v[220:223], v[52:55], v[76:79], v[220:223]
    ds_read_b128 v[104:107], v21 offset:12288
    v_mfma_f32_16x16x32_bf16 v[216:219], v[52:55], v[72:75], v[216:219]
    v_mfma_f32_16x16x32_bf16 v[212:215], v[52:55], v[68:71], v[212:215]
    ds_read_b128 v[108:111], v21 offset:14336
    v_mfma_f32_16x16x32_bf16 v[208:211], v[52:55], v[64:67], v[208:211]
    s_add_u32 s59, s59, 1
    v_mfma_f32_16x16x32_bf16 v[224:227], v[56:59], v[64:67], v[224:227]
    s_cmp_eq_u32 s59, 3
    v_mfma_f32_16x16x32_bf16 v[228:231], v[56:59], v[68:71], v[228:231]
    s_cselect_b32 s60, s61, s66
    v_mfma_f32_16x16x32_bf16 v[232:235], v[56:59], v[72:75], v[232:235]
    s_cselect_b32 s59, 0, s59
    v_mfma_f32_16x16x32_bf16 v[236:239], v[56:59], v[76:79], v[236:239]
    v_add_u32 v20, s60, v20
    v_mfma_f32_16x16x32_bf16 v[252:255], v[60:63], v[76:79], v[252:255]
    v_add_u32 v24, s60, v24
    v_mfma_f32_16x16x32_bf16 v[248:251], v[60:63], v[72:75], v[248:251]
    v_mfma_f32_16x16x32_bf16 v[244:247], v[60:63], v[68:71], v[244:247]
    v_mfma_f32_16x16x32_bf16 v[240:243], v[60:63], v[64:67], v[240:243]
    s_waitcnt lgkmcnt(0)
    v_mfma_f32_16x16x32_bf16 v[128:131], v[80:83], v[112:115], v[128:131]
    s_barrier
    v_mfma_f32_16x16x32_bf16 v[132:135], v[80:83], v[116:119], v[132:135]
    ds_read_b128 v[32:35], v20 offset:0
    v_mfma_f32_16x16x32_bf16 v[136:139], v[80:83], v[120:123], v[136:139]
    v_mfma_f32_16x16x32_bf16 v[140:143], v[80:83], v[124:127], v[140:143]
    ds_read_b128 v[64:67], v24 offset:0
    v_mfma_f32_16x16x32_bf16 v[156:159], v[84:87], v[124:127], v[156:159]
    v_mfma_f32_16x16x32_bf16 v[152:155], v[84:87], v[120:123], v[152:155]
    ds_read_b128 v[68:71], v24 offset:2048
    v_mfma_f32_16x16x32_bf16 v[148:151], v[84:87], v[116:119], v[148:151]
    v_mfma_f32_16x16x32_bf16 v[144:147], v[84:87], v[112:115], v[144:147]
    ds_read_b128 v[72:75], v24 offset:4096
    v_mfma_f32_16x16x32_bf16 v[160:163], v[88:91], v[112:115], v[160:163]
    v_mfma_f32_16x16x32_bf16 v[164:167], v[88:91], v[116:119], v[164:167]
    ds_read_b128 v[76:79], v24 offset:6144
    v_mfma_f32_16x16x32_bf16 v[168:171], v[88:91], v[120:123], v[168:171]
    v_mfma_f32_16x16x32_bf16 v[172:175], v[88:91], v[124:127], v[172:175]
    ds_read_b128 v[36:39], v20 offset:2048
    v_mfma_f32_16x16x32_bf16 v[188:191], v[92:95], v[124:127], v[188:191]
    v_mfma_f32_16x16x32_bf16 v[184:187], v[92:95], v[120:123], v[184:187]
    ds_read_b128 v[40:43], v20 offset:4096
    v_mfma_f32_16x16x32_bf16 v[180:183], v[92:95], v[116:119], v[180:183]
    v_mfma_f32_16x16x32_bf16 v[176:179], v[92:95], v[112:115], v[176:179]
    ds_read_b128 v[44:47], v20 offset:6144
    v_mfma_f32_16x16x32_bf16 v[192:195], v[96:99], v[112:115], v[192:195]
    v_mfma_f32_16x16x32_bf16 v[196:199], v[96:99], v[116:119], v[196:199]
    ds_read_b128 v[48:51], v20 offset:8192
    v_mfma_f32_16x16x32_bf16 v[200:203], v[96:99], v[120:123], v[200:203]
    v_mfma_f32_16x16x32_bf16 v[204:207], v[96:99], v[124:127], v[204:207]
    ds_read_b128 v[52:55], v20 offset:10240
    v_mfma_f32_16x16x32_bf16 v[220:223], v[100:103], v[124:127], v[220:223]
    v_mfma_f32_16x16x32_bf16 v[216:219], v[100:103], v[120:123], v[216:219]
    ds_read_b128 v[56:59], v20 offset:12288
    v_mfma_f32_16x16x32_bf16 v[212:215], v[100:103], v[116:119], v[212:215]
    v_mfma_f32_16x16x32_bf16 v[208:211], v[100:103], v[112:115], v[208:211]
    ds_read_b128 v[60:63], v20 offset:14336
    v_mfma_f32_16x16x32_bf16 v[224:227], v[104:107], v[112:115], v[224:227]
    v_add_u32 v21, s60, v21
    v_mfma_f32_16x16x32_bf16 v[228:231], v[104:107], v[116:119], v[228:231]
    v_add_u32 v25, s60, v25
    v_mfma_f32_16x16x32_bf16 v[232:235], v[104:107], v[120:123], v[232:235]
    s_sub_u32 s58, s58, 1
    v_mfma_f32_16x16x32_bf16 v[236:239], v[104:107], v[124:127], v[236:239]
    s_cmp_lg_u32 s58, 0
    v_mfma_f32_16x16x32_bf16 v[252:255], v[108:111], v[124:127], v[252:255]
    v_mfma_f32_16x16x32_bf16 v[248:251], v[108:111], v[120:123], v[248:251]
    v_mfma_f32_16x16x32_bf16 v[244:247], v[108:111], v[116:119], v[244:247]
    v_mfma_f32_16x16x32_bf16 v[240:243], v[108:111], v[112:115], v[240:243]
    s_cbranch_scc1 L_cA_loop
    s_waitcnt lgkmcnt(0)
    v_and_b32 v1, 15, v0
    v_lshlrev_b32 v2, 3, v1
    s_lshl_b32 s48, s47, 7
    v_add_u32 v2, s48, v2
    v_add_u32 v2, 147456, v2
    ds_read_b64 v[32:33], v2 offset:0
    ds_read_b64 v[34:35], v2 offset:256
    ds_read_b64 v[36:37], v2 offset:512
    ds_read_b64 v[38:39], v2 offset:768
    ds_read_b64 v[40:41], v2 offset:1024
    ds_read_b64 v[42:43], v2 offset:1280
    ds_read_b64 v[44:45], v2 offset:1536
    ds_read_b64 v[46:47], v2 offset:1792
    ds_read_b64 v[48:49], v2 offset:2048
    ds_read_b64 v[50:51], v2 offset:2304
    s_waitcnt lgkmcnt(8)
    v_pk_fma_f32 v[130:131], v[34:35], v[136:137], v[130:131] op_sel:[0,0,0] op_sel_hi:[0,1,1] neg_lo:[1,0,0] neg_hi:[1,0,0]
    v_pk_fma_f32 v[134:135], v[34:35], v[140:141], v[134:135] op_sel:[1,0,0] op_sel_hi:[1,1,1] neg_lo:[1,0,0] neg_hi:[1,0,0]
    v_pk_fma_f32 v[138:139], v[34:35], v[128:129], v[138:139] op_sel:[0,0,0] op_sel_hi:[0,1,1]
    v_pk_fma_f32 v[142:143], v[34:35], v[132:133], v[142:143] op_sel:[1,0,0] op_sel_hi:[1,1,1]
    v_pk_fma_f32 v[130:131], v[32:33], v[128:129], v[130:131] op_sel:[0,0,0] op_sel_hi:[0,1,1]
    v_pk_fma_f32 v[134:135], v[32:33], v[132:133], v[134:135] op_sel:[1,0,0] op_sel_hi:[1,1,1]
    v_pk_fma_f32 v[138:139], v[32:33], v[136:137], v[138:139] op_sel:[0,0,0] op_sel_hi:[0,1,1]
    v_pk_fma_f32 v[142:143], v[32:33], v[140:141], v[142:143] op_sel:[1,0,0] op_sel_hi:[1,1,1]
    v_pk_fma_f32 v[144:145], v[34:35], v[138:139], v[144:145] op_sel:[0,0,0] op_sel_hi:[0,1,1] neg_lo:[1,0,0] neg_hi:[1,0,0]
    v_pk_fma_f32 v[148:149], v[34:35], v[142:143], v[148:149] op_sel:[1,0,0] op_sel_hi:[1,1,1] neg_lo:[1,0,0] neg_hi:[1,0,0]
    v_pk_fma_f32 v[152:153], v[34:35], v[130:131], v[152:153] op_sel:[0,0,0] op_sel_hi:[0,1,1]
    v_pk_fma_f32 v[156:157], v[34:35], v[134:135], v[156:157] op_sel:[1,0,0] op_sel_hi:[1,1,1]
    v_pk_fma_f32 v[144:145], v[32:33], v[130:131], v[144:145] op_sel:[0,0,0] op_sel_hi:[0,1,1]
    v_pk_fma_f32 v[148:149], v[32:33], v[134:135], v[148:149] op_sel:[1,0,0] op_sel_hi:[1,1,1]
    v_pk_fma_f32 v[152:153], v[32:33], v[138:139], v[152:153] op_sel:[0,0,0] op_sel_hi:[0,1,1]
    v_pk_fma_f32 v[156:157], v[32:33], v[142:143], v[156:157] op_sel:[1,0,0] op_sel_hi:[1,1,1]
    v_pk_fma_f32 v[146:147], v[34:35], v[152:153], v[146:147] op_sel:[0,0,0] op_sel_hi:[0,1,1] neg_lo:[1,0,0] neg_hi:[1,0,0]
    v_pk_fma_f32 v[150:151], v[34:35], v[156:157], v[150:151] op_sel:[1,0,0] op_sel_hi:[1,1,1] neg_lo:[1,0,0] neg_hi:[1,0,0]
    v_pk_fma_f32 v[154:155], v[34:35], v[144:145], v[154:155] op_sel:[0,0,0] op_sel_hi:[0,1,1]
    v_pk_fma_f32 v[158:159], v[34:35], v[148:149], v[158:159] op_sel:[1,0,0] op_sel_hi:[1,1,1]
    v_pk_fma_f32 v[146:147], v[32:33], v[144:145], v[146:147] op_sel:[0,0,0] op_sel_hi:[0,1,1]
    v_pk_fma_f32 v[150:151], v[32:33], v[148:149], v[150:151] op_sel:[1,0,0] op_sel_hi:[1,1,1]
    v_pk_fma_f32 v[154:155], v[32:33], v[152:153], v[154:155] op_sel:[0,0,0] op_sel_hi:[0,1,1]
    v_pk_fma_f32 v[158:159], v[32:33], v[156:157], v[158:159] op_sel:[1,0,0] op_sel_hi:[1,1,1]
    v_pk_fma_f32 v[160:161], v[34:35], v[154:155], v[160:161] op_sel:[0,0,0] op_sel_hi:[0,1,1] neg_lo:[1,0,0] neg_hi:[1,0,0]
    v_pk_fma_f32 v[164:165], v[34:35], v[158:159], v[164:165] op_sel:[1,0,0] op_sel_hi:[1,1,1] neg_lo:[1,0,0] neg_hi:[1,0,0]
    v_pk_fma_f32 v[168:169], v[34:35], v[146:147], v[168:169] op_sel:[0,0,0] op_sel_hi:[0,1,1]
    v_pk_fma_f32 v[172:173], v[34:35], v[150:151], v[172:173] op_sel:[1,0,0] op_sel_hi:[1,1,1]
    v_pk_fma_f32 v[160:161], v[32:33], v[146:147], v[160:161] op_sel:[0,0,0] op_sel_hi:[0,1,1]
    v_pk_fma_f32 v[164:165], v[32:33], v[150:151], v[164:165] op_sel:[1,0,0] op_sel_hi:[1,1,1]
    v_pk_fma_f32 v[168:169], v[32:33], v[154:155], v[168:169] op_sel:[0,0,0] op_sel_hi:[0,1,1]
    v_pk_fma_f32 v[172:173], v[32:33], v[158:159], v[172:173] op_sel:[1,0,0] op_sel_hi:[1,1,1]
    v_pk_fma_f32 v[162:163], v[34:35], v[168:169], v[162:163] op_sel:[0,0,0] op_sel_hi:[0,1,1] neg_lo:[1,0,0] neg_hi:[1,0,0]
    v_pk_fma_f32 v[166:167], v[34:35], v[172:173], v[166:167] op_sel:[1,0,0] op_sel_hi:[1,1,1] neg_lo:[1,0,0] neg_hi:[1,0,0]
    v_pk_fma_f32 v[170:171], v[34:35], v[160:161], v[170:171] op_sel:[0,0,0] op_sel_hi:[0,1,1]
    v_pk_fma_f32 v[174:175], v[34:35], v[164:165], v[174:175] op_sel:[1,0,0] op_sel_hi:[1,1,1]
    v_pk_fma_f32 v[162:163], v[32:33], v[160:161], v[162:163] op_sel:[0,0,0] op_sel_hi:[0,1,1]
    v_pk_fma_f32 v[166:167], v[32:33], v[164:165], v[166:167] op_sel:[1,0,0] op_sel_hi:[1,1,1]
    v_pk_fma_f32 v[170:171], v[32:33], v[168:169], v[170:171] op_sel:[0,0,0] op_sel_hi:[0,1,1]
    v_pk_fma_f32 v[174:175], v[32:33], v[172:173], v[174:175] op_sel:[1,0,0] op_sel_hi:[1,1,1]
    v_pk_fma_f32 v[176:177], v[34:35], v[170:171], v[176:177] op_sel:[0,0,0] op_sel_hi:[0,1,1] neg_lo:[1,0,0] neg_hi:[1,0,0]
    v_pk_fma_f32 v[180:181], v[34:35], v[174:175], v[180:181] op_sel:[1,0,0] op_sel_hi:[1,1,1] neg_lo:[1,0,0] neg_hi:[1,0,0]
    v_pk_fma_f32 v[184:185], v[34:35], v[162:163], v[184:185] op_sel:[0,0,0] op_sel_hi:[0,1,1]
    v_pk_fma_f32 v[188:189], v[34:35], v[166:167], v[188:189] op_sel:[1,0,0] op_sel_hi:[1,1,1]
    v_pk_fma_f32 v[176:177], v[32:33], v[162:163], v[176:177] op_sel:[0,0,0] op_sel_hi:[0,1,1]
    v_pk_fma_f32 v[180:181], v[32:33], v[166:167], v[180:181] op_sel:[1,0,0] op_sel_hi:[1,1,1]
    v_pk_fma_f32 v[184:185], v[32:33], v[170:171], v[184:185] op_sel:[0,0,0] op_sel_hi:[0,1,1]
    v_pk_fma_f32 v[188:189], v[32:33], v[174:175], v[188:189] op_sel:[1,0,0] op_sel_hi:[1,1,1]
    v_pk_fma_f32 v[178:179], v[34:35], v[184:185], v[178:179] op_sel:[0,0,0] op_sel_hi:[0,1,1] neg_lo:[1,0,0] neg_hi:[1,0,0]
    v_pk_fma_f32 v[182:183], v[34:35], v[188:189], v[182:183] op_sel:[1,0,0] op_sel_hi:[1,1,1] neg_lo:[1,0,0] neg_hi:[1,0,0]
    v_pk_fma_f32 v[186:187], v[34:35], v[176:177], v[186:187] op_sel:[0,0,0] op_sel_hi:[0,1,1]
    v_pk_fma_f32 v[190:191], v[34:35], v[180:181], v[190:191] op_sel:[1,0,0] op_sel_hi:[1,1,1]
    v_pk_fma_f32 v[178:179], v[32:33], v[176:177], v[178:179] op_sel:[0,0,0] op_sel_hi:[0,1,1]
    v_pk_fma_f32 v[182:183], v[32:33], v[180:181], v[182:183] op_sel:[1,0,0] op_sel_hi:[1,1,1]
    v_pk_fma_f32 v[186:187], v[32:33], v[184:185], v[186:187] op_sel:[0,0,0] op_sel_hi:[0,1,1]
    v_pk_fma_f32 v[190:191], v[32:33], v[188:189], v[190:191] op_sel:[1,0,0] op_sel_hi:[1,1,1]
    v_pk_fma_f32 v[192:193], v[34:35], v[186:187], v[192:193] op_sel:[0,0,0] op_sel_hi:[0,1,1] neg_lo:[1,0,0] neg_hi:[1,0,0]
    v_pk_fma_f32 v[196:197], v[34:35], v[190:191], v[196:197] op_sel:[1,0,0] op_sel_hi:[1,1,1] neg_lo:[1,0,0] neg_hi:[1,0,0]
    v_pk_fma_f32 v[200:201], v[34:35], v[178:179], v[200:201] op_sel:[0,0,0] op_sel_hi:[0,1,1]
    v_pk_fma_f32 v[204:205], v[34:35], v[182:183], v[204:205] op_sel:[1,0,0] op_sel_hi:[1,1,1]
    v_pk_fma_f32 v[192:193], v[32:33], v[178:179], v[192:193] op_sel:[0,0,0] op_sel_hi:[0,1,1]
    v_pk_fma_f32 v[196:197], v[32:33], v[182:183], v[196:197] op_sel:[1,0,0] op_sel_hi:[1,1,1]
    v_pk_fma_f32 v[200:201], v[32:33], v[186:187], v[200:201] op_sel:[0,0,0] op_sel_hi:[0,1,1]
    v_pk_fma_f32 v[204:205], v[32:33], v[190:191], v[204:205] op_sel:[1,0,0] op_sel_hi:[1,1,1]
    v_pk_fma_f32 v[194:195], v[34:35], v[200:201], v[194:195] op_sel:[0,0,0] op_sel_hi:[0,1,1] neg_lo:[1,0,0] neg_hi:[1,0,0]
    v_pk_fma_f32 v[198:199], v[34:35], v[204:205], v[198:199] op_sel:[1,0,0] op_sel_hi:[1,1,1] neg_lo:[1,0,0] neg_hi:[1,0,0]
    v_pk_fma_f32 v[202:203], v[34:35], v[192:193], v[202:203] op_sel:[0,0,0] op_sel_hi:[0,1,1]
    v_pk_fma_f32 v[206:207], v[34:35], v[196:197], v[206:207] op_sel:[1,0,0] op_sel_hi:[1,1,1]
    v_pk_fma_f32 v[194:195], v[32:33], v[192:193], v[194:195] op_sel:[0,0,0] op_sel_hi:[0,1,1]
    v_pk_fma_f32 v[198:199], v[32:33], v[196:197], v[198:199] op_sel:[1,0,0] op_sel_hi:[1,1,1]
    v_pk_fma_f32 v[202:203], v[32:33], v[200:201], v[202:203] op_sel:[0,0,0] op_sel_hi:[0,1,1]
    v_pk_fma_f32 v[206:207], v[32:33], v[204:205], v[206:207] op_sel:[1,0,0] op_sel_hi:[1,1,1]
    v_pk_fma_f32 v[208:209], v[34:35], v[202:203], v[208:209] op_sel:[0,0,0] op_sel_hi:[0,1,1] neg_lo:[1,0,0] neg_hi:[1,0,0]
    v_pk_fma_f32 v[212:213], v[34:35], v[206:207], v[212:213] op_sel:[1,0,0] op_sel_hi:[1,1,1] neg_lo:[1,0,0] neg_hi:[1,0,0]
    v_pk_fma_f32 v[216:217], v[34:35], v[194:195], v[216:217] op_sel:[0,0,0] op_sel_hi:[0,1,1]
    v_pk_fma_f32 v[220:221], v[34:35], v[198:199], v[220:221] op_sel:[1,0,0] op_sel_hi:[1,1,1]
    v_pk_fma_f32 v[208:209], v[32:33], v[194:195], v[208:209] op_sel:[0,0,0] op_sel_hi:[0,1,1]
    v_pk_fma_f32 v[212:213], v[32:33], v[198:199], v[212:213] op_sel:[1,0,0] op_sel_hi:[1,1,1]
    v_pk_fma_f32 v[216:217], v[32:33], v[202:203], v[216:217] op_sel:[0,0,0] op_sel_hi:[0,1,1]
    v_pk_fma_f32 v[220:221], v[32:33], v[206:207], v[220:221] op_sel:[1,0,0] op_sel_hi:[1,1,1]
    v_pk_fma_f32 v[210:211], v[34:35], v[216:217], v[210:211] op_sel:[0,0,0] op_sel_hi:[0,1,1] neg_lo:[1,0,0] neg_hi:[1,0,0]
    v_pk_fma_f32 v[214:215], v[34:35], v[220:221], v[214:215] op_sel:[1,0,0] op_sel_hi:[1,1,1] neg_lo:[1,0,0] neg_hi:[1,0,0]
    v_pk_fma_f32 v[218:219], v[34:35], v[208:209], v[218:219] op_sel:[0,0,0] op_sel_hi:[0,1,1]
    v_pk_fma_f32 v[222:223], v[34:35], v[212:213], v[222:223] op_sel:[1,0,0] op_sel_hi:[1,1,1]
    v_pk_fma_f32 v[210:211], v[32:33], v[208:209], v[210:211] op_sel:[0,0,0] op_sel_hi:[0,1,1]
    v_pk_fma_f32 v[214:215], v[32:33], v[212:213], v[214:215] op_sel:[1,0,0] op_sel_hi:[1,1,1]
    v_pk_fma_f32 v[218:219], v[32:33], v[216:217], v[218:219] op_sel:[0,0,0] op_sel_hi:[0,1,1]
    v_pk_fma_f32 v[222:223], v[32:33], v[220:221], v[222:223] op_sel:[1,0,0] op_sel_hi:[1,1,1]
    v_pk_fma_f32 v[224:225], v[34:35], v[218:219], v[224:225] op_sel:[0,0,0] op_sel_hi:[0,1,1] neg_lo:[1,0,0] neg_hi:[1,0,0]
    v_pk_fma_f32 v[228:229], v[34:35], v[222:223], v[228:229] op_sel:[1,0,0] op_sel_hi:[1,1,1] neg_lo:[1,0,0] neg_hi:[1,0,0]
    v_pk_fma_f32 v[232:233], v[34:35], v[210:211], v[232:233] op_sel:[0,0,0] op_sel_hi:[0,1,1]
    v_pk_fma_f32 v[236:237], v[34:35], v[214:215], v[236:237] op_sel:[1,0,0] op_sel_hi:[1,1,1]
    v_pk_fma_f32 v[224:225], v[32:33], v[210:211], v[224:225] op_sel:[0,0,0] op_sel_hi:[0,1,1]
    v_pk_fma_f32 v[228:229], v[32:33], v[214:215], v[228:229] op_sel:[1,0,0] op_sel_hi:[1,1,1]
    v_pk_fma_f32 v[232:233], v[32:33], v[218:219], v[232:233] op_sel:[0,0,0] op_sel_hi:[0,1,1]
    v_pk_fma_f32 v[236:237], v[32:33], v[222:223], v[236:237] op_sel:[1,0,0] op_sel_hi:[1,1,1]
    v_pk_fma_f32 v[226:227], v[34:35], v[232:233], v[226:227] op_sel:[0,0,0] op_sel_hi:[0,1,1] neg_lo:[1,0,0] neg_hi:[1,0,0]
    v_pk_fma_f32 v[230:231], v[34:35], v[236:237], v[230:231] op_sel:[1,0,0] op_sel_hi:[1,1,1] neg_lo:[1,0,0] neg_hi:[1,0,0]
    v_pk_fma_f32 v[234:235], v[34:35], v[224:225], v[234:235] op_sel:[0,0,0] op_sel_hi:[0,1,1]
    v_pk_fma_f32 v[238:239], v[34:35], v[228:229], v[238:239] op_sel:[1,0,0] op_sel_hi:[1,1,1]
    v_pk_fma_f32 v[226:227], v[32:33], v[224:225], v[226:227] op_sel:[0,0,0] op_sel_hi:[0,1,1]
    v_pk_fma_f32 v[230:231], v[32:33], v[228:229], v[230:231] op_sel:[1,0,0] op_sel_hi:[1,1,1]
    v_pk_fma_f32 v[234:235], v[32:33], v[232:233], v[234:235] op_sel:[0,0,0] op_sel_hi:[0,1,1]
    v_pk_fma_f32 v[238:239], v[32:33], v[236:237], v[238:239] op_sel:[1,0,0] op_sel_hi:[1,1,1]
    v_pk_fma_f32 v[240:241], v[34:35], v[234:235], v[240:241] op_sel:[0,0,0] op_sel_hi:[0,1,1] neg_lo:[1,0,0] neg_hi:[1,0,0]
    v_pk_fma_f32 v[244:245], v[34:35], v[238:239], v[244:245] op_sel:[1,0,0] op_sel_hi:[1,1,1] neg_lo:[1,0,0] neg_hi:[1,0,0]
    v_pk_fma_f32 v[248:249], v[34:35], v[226:227], v[248:249] op_sel:[0,0,0] op_sel_hi:[0,1,1]
    v_pk_fma_f32 v[252:253], v[34:35], v[230:231], v[252:253] op_sel:[1,0,0] op_sel_hi:[1,1,1]
    v_pk_fma_f32 v[240:241], v[32:33], v[226:227], v[240:241] op_sel:[0,0,0] op_sel_hi:[0,1,1]
    v_pk_fma_f32 v[244:245], v[32:33], v[230:231], v[244:245] op_sel:[1,0,0] op_sel_hi:[1,1,1]
    v_pk_fma_f32 v[248:249], v[32:33], v[234:235], v[248:249] op_sel:[0,0,0] op_sel_hi:[0,1,1]
    v_pk_fma_f32 v[252:253], v[32:33], v[238:239], v[252:253] op_sel:[1,0,0] op_sel_hi:[1,1,1]
    v_pk_fma_f32 v[242:243], v[34:35], v[248:249], v[242:243] op_sel:[0,0,0] op_sel_hi:[0,1,1] neg_lo:[1,0,0] neg_hi:[1,0,0]
    v_pk_fma_f32 v[246:247], v[34:35], v[252:253], v[246:247] op_sel:[1,0,0] op_sel_hi:[1,1,1] neg_lo:[1,0,0] neg_hi:[1,0,0]
    v_pk_fma_f32 v[250:251], v[34:35], v[240:241], v[250:251] op_sel:[0,0,0] op_sel_hi:[0,1,1]
    v_pk_fma_f32 v[254:255], v[34:35], v[244:245], v[254:255] op_sel:[1,0,0] op_sel_hi:[1,1,1]
    v_pk_fma_f32 v[242:243], v[32:33], v[240:241], v[242:243] op_sel:[0,0,0] op_sel_hi:[0,1,1]
    v_pk_fma_f32 v[246:247], v[32:33], v[244:245], v[246:247] op_sel:[1,0,0] op_sel_hi:[1,1,1]
    v_pk_fma_f32 v[250:251], v[32:33], v[248:249], v[250:251] op_sel:[0,0,0] op_sel_hi:[0,1,1]
    v_pk_fma_f32 v[254:255], v[32:33], v[252:253], v[254:255] op_sel:[1,0,0] op_sel_hi:[1,1,1]
    v_mov_b32 v52, v242
    v_mov_b32 v54, v250
    v_mov_b32 v56, v243
    v_mov_b32 v58, v251
    v_mov_b32 v53, v246
    v_mov_b32 v55, v254
    v_mov_b32 v57, v247
    v_mov_b32 v59, v255
    s_waitcnt lgkmcnt(4)
    v_pk_fma_f32 v[62:63], v[42:43], v[52:53], v[58:59] op_sel:[0,0,0] op_sel_hi:[1,1,1]
    v_pk_fma_f32 v[60:61], v[40:41], v[52:53], v[56:57] op_sel:[0,0,0] op_sel_hi:[1,1,1]
    v_pk_fma_f32 v[60:61], v[42:43], v[54:55], v[60:61] op_sel:[0,0,0] op_sel_hi:[1,1,1] neg_lo:[1,0,0] neg_hi:[1,0,0]
    v_pk_fma_f32 v[62:63], v[40:41], v[54:55], v[62:63] op_sel:[0,0,0] op_sel_hi:[1,1,1]
    v_lshrrev_b32 v3, 4, v0
    s_lshl_b32 s48, s46, 2
    v_add_u32 v3, s48, v3
    v_lshlrev_b32 v3, 9, v3
    v_lshlrev_b32 v4, 4, v1
    s_lshl_b32 s48, s47, 8
    v_add_u32 v4, s48, v4
    v_add_u32 v4, 151552, v4
    v_add_u32 v3, v3, v4
    ds_write_b128 v3, v[60:63]
    s_waitcnt lgkmcnt(0)
    s_barrier
    ds_read_b128 v[64:67], v4 offset:0
    ds_read_b128 v[68:71], v4 offset:512
    ds_read_b128 v[72:75], v4 offset:1024
    ds_read_b128 v[76:79], v4 offset:1536
    ds_read_b128 v[80:83], v4 offset:2048
    ds_read_b128 v[84:87], v4 offset:2560
    ds_read_b128 v[88:91], v4 offset:3072
    v_mov_b32 v92, 0
    v_mov_b32 v93, 0
    v_mov_b32 v94, 0
    v_mov_b32 v95, 0
    v_mov_b32 v98, 0
    v_mov_b32 v99, 0
    v_mov_b32 v96, 1.0
    v_mov_b32 v97, 1.0
    s_cmp_eq_u32 s46, 0
    s_cbranch_scc1 L_h0
    s_waitcnt lgkmcnt(6)
    v_pk_fma_f32 v[100:101], v[46:47], v[92:93], v[66:67] op_sel:[0,0,0] op_sel_hi:[1,1,1]
    v_pk_fma_f32 v[92:93], v[44:45], v[92:93], v[64:65] op_sel:[0,0,0] op_sel_hi:[1,1,1]
    v_pk_fma_f32 v[92:93], v[46:47], v[94:95], v[92:93] op_sel:[0,0,0] op_sel_hi:[1,1,1] neg_lo:[1,0,0] neg_hi:[1,0,0]
    v_pk_fma_f32 v[94:95], v[44:45], v[94:95], v[100:101] op_sel:[0,0,0] op_sel_hi:[1,1,1]
    s_waitcnt lgkmcnt(5)
    v_pk_fma_f32 v[100:101], v[46:47], v[92:93], v[70:71] op_sel:[0,0,0] op_sel_hi:[1,1,1]
    v_pk_fma_f32 v[92:93], v[44:45], v[92:93], v[68:69] op_sel:[0,0,0] op_sel_hi:[1,1,1]
    v_pk_fma_f32 v[92:93], v[46:47], v[94:95], v[92:93] op_sel:[0,0,0] op_sel_hi:[1,1,1] neg_lo:[1,0,0] neg_hi:[1,0,0]
    v_pk_fma_f32 v[94:95], v[44:45], v[94:95], v[100:101] op_sel:[0,0,0] op_sel_hi:[1,1,1]
    s_waitcnt lgkmcnt(4)
    v_pk_fma_f32 v[100:101], v[46:47], v[92:93], v[74:75] op_sel:[0,0,0] op_sel_hi:[1,1,1]
    v_pk_fma_f32 v[92:93], v[44:45], v[92:93], v[72:73] op_sel:[0,0,0] op_sel_hi:[1,1,1]
    v_pk_fma_f32 v[92:93], v[46:47], v[94:95], v[92:93] op_sel:[0,0,0] op_sel_hi:[1,1,1] neg_lo:[1,0,0] neg_hi:[1,0,0]
    v_pk_fma_f32 v[94:95], v[44:45], v[94:95], v[100:101] op_sel:[0,0,0] op_sel_hi:[1,1,1]
    s_waitcnt lgkmcnt(3)
    v_pk_fma_f32 v[100:101], v[46:47], v[92:93], v[78:79] op_sel:[0,0,0] op_sel_hi:[1,1,1]
    v_pk_fma_f32 v[92:93], v[44:45], v[92:93], v[76:77] op_sel:[0,0,0] op_sel_hi:[1,1,1]
    v_pk_fma_f32 v[92:93], v[46:47], v[94:95], v[92:93] op_sel:[0,0,0] op_sel_hi:[1,1,1] neg_lo:[1,0,0] neg_hi:[1,0,0]
    v_pk_fma_f32 v[94:95], v[44:45], v[94:95], v[100:101] op_sel:[0,0,0] op_sel_hi:[1,1,1]
    s_mov_b32 exec_lo, 0xffff0000
    s_mov_b32 exec_hi, -1
    s_waitcnt lgkmcnt(2)
    v_pk_fma_f32 v[100:101], v[46:47], v[92:93], v[82:83] op_sel:[0,0,0] op_sel_hi:[1,1,1]
    v_pk_fma_f32 v[92:93], v[44:45], v[92:93], v[80:81] op_sel:[0,0,0] op_sel_hi:[1,1,1]
    v_pk_fma_f32 v[92:93], v[46:47], v[94:95], v[92:93] op_sel:[0,0,0] op_sel_hi:[1,1,1] neg_lo:[1,0,0] neg_hi:[1,0,0]
    v_pk_fma_f32 v[94:95], v[44:45], v[94:95], v[100:101] op_sel:[0,0,0] op_sel_hi:[1,1,1]
    s_mov_b32 exec_lo, 0
    s_mov_b32 exec_hi, -1
    s_waitcnt lgkmcnt(1)
    v_pk_fma_f32 v[100:101], v[46:47], v[92:93], v[86:87] op_sel:[0,0,0] op_sel_hi:[1,1,1]
    v_pk_fma_f32 v[92:93], v[44:45], v[92:93], v[84:85] op_sel:[0,0,0] op_sel_hi:[1,1,1]
    v_pk_fma_f32 v[92:93], v[46:47], v[94:95], v[92:93] op_sel:[0,0,0] op_sel_hi:[1,1,1] neg_lo:[1,0,0] neg_hi:[1,0,0]
    v_pk_fma_f32 v[94:95], v[44:45], v[94:95], v[100:101] op_sel:[0,0,0] op_sel_hi:[1,1,1]
    s_mov_b32 exec_lo, 0
    s_mov_b32 exec_hi, 0xffff0000
    s_waitcnt lgkmcnt(0)
    v_pk_fma_f32 v[100:101], v[46:47], v[92:93], v[90:91] op_sel:[0,0,0] op_sel_hi:[1,1,1]
    v_pk_fma_f32 v[92:93], v[44:45], v[92:93], v[88:89] op_sel:[0,0,0] op_sel_hi:[1,1,1]
    v_pk_fma_f32 v[92:93], v[46:47], v[94:95], v[92:93] op_sel:[0,0,0] op_sel_hi:[1,1,1] neg_lo:[1,0,0] neg_hi:[1,0,0]
    v_pk_fma_f32 v[94:95], v[44:45], v[94:95], v[100:101] op_sel:[0,0,0] op_sel_hi:[1,1,1]
    v_pk_fma_f32 v[110:111], v[46:47], v[92:93], v[62:63] op_sel:[0,0,0] op_sel_hi:[1,1,1]
    v_pk_fma_f32 v[108:109], v[44:45], v[92:93], v[60:61] op_sel:[0,0,0] op_sel_hi:[1,1,1]
    v_pk_fma_f32 v[108:109], v[46:47], v[94:95], v[108:109] op_sel:[0,0,0] op_sel_hi:[1,1,1] neg_lo:[1,0,0] neg_hi:[1,0,0]
    v_pk_fma_f32 v[110:111], v[44:45], v[94:95], v[110:111] op_sel:[0,0,0] op_sel_hi:[1,1,1]
    s_lshl_b32 s48, s41, 3
    s_add_u32 s48, s48, s40
    s_lshl_b32 s48, s48, 10
    s_lshl_b32 s49, s47, 8
    s_add_u32 s48, s48, s49
    s_add_u32 s48, s48, 16777216
    v_lshlrev_b32 v5, 4, v1
    buffer_store_dwordx4 v[108:111], v5, s[20:23], s48 offen sc1
    s_mov_b64 exec, -1
    v_pk_mul_f32 v[104:105], v[46:47], v[96:97] op_sel:[0,0] op_sel_hi:[1,1]
    v_pk_mul_f32 v[96:97], v[44:45], v[96:97] op_sel:[0,0] op_sel_hi:[1,1]
    v_pk_fma_f32 v[96:97], v[46:47], v[98:99], v[96:97] op_sel:[0,0,0] op_sel_hi:[1,1,1] neg_lo:[1,0,0] neg_hi:[1,0,0]
    v_pk_fma_f32 v[98:99], v[44:45], v[98:99], v[104:105] op_sel:[0,0,0] op_sel_hi:[1,1,1]
    v_pk_mul_f32 v[104:105], v[46:47], v[96:97] op_sel:[0,0] op_sel_hi:[1,1]
    v_pk_mul_f32 v[96:97], v[44:45], v[96:97] op_sel:[0,0] op_sel_hi:[1,1]
    v_pk_fma_f32 v[96:97], v[46:47], v[98:99], v[96:97] op_sel:[0,0,0] op_sel_hi:[1,1,1] neg_lo:[1,0,0] neg_hi:[1,0,0]
    v_pk_fma_f32 v[98:99], v[44:45], v[98:99], v[104:105] op_sel:[0,0,0] op_sel_hi:[1,1,1]
    v_pk_mul_f32 v[104:105], v[46:47], v[96:97] op_sel:[0,0] op_sel_hi:[1,1]
    v_pk_mul_f32 v[96:97], v[44:45], v[96:97] op_sel:[0,0] op_sel_hi:[1,1]
    v_pk_fma_f32 v[96:97], v[46:47], v[98:99], v[96:97] op_sel:[0,0,0] op_sel_hi:[1,1,1] neg_lo:[1,0,0] neg_hi:[1,0,0]
    v_pk_fma_f32 v[98:99], v[44:45], v[98:99], v[104:105] op_sel:[0,0,0] op_sel_hi:[1,1,1]
    v_pk_mul_f32 v[104:105], v[46:47], v[96:97] op_sel:[0,0] op_sel_hi:[1,1]
    v_pk_mul_f32 v[96:97], v[44:45], v[96:97] op_sel:[0,0] op_sel_hi:[1,1]
    v_pk_fma_f32 v[96:97], v[46:47], v[98:99], v[96:97] op_sel:[0,0,0] op_sel_hi:[1,1,1] neg_lo:[1,0,0] neg_hi:[1,0,0]
    v_pk_fma_f32 v[98:99], v[44:45], v[98:99], v[104:105] op_sel:[0,0,0] op_sel_hi:[1,1,1]
    s_mov_b32 exec_lo, 0xffff0000
    s_mov_b32 exec_hi, -1
    v_pk_mul_f32 v[104:105], v[46:47], v[96:97] op_sel:[0,0] op_sel_hi:[1,1]
    v_pk_mul_f32 v[96:97], v[44:45], v[96:97] op_sel:[0,0] op_sel_hi:[1,1]
    v_pk_fma_f32 v[96:97], v[46:47], v[98:99], v[96:97] op_sel:[0,0,0] op_sel_hi:[1,1,1] neg_lo:[1,0,0] neg_hi:[1,0,0]
    v_pk_fma_f32 v[98:99], v[44:45], v[98:99], v[104:105] op_sel:[0,0,0] op_sel_hi:[1,1,1]
    s_mov_b32 exec_lo, 0
    s_mov_b32 exec_hi, -1
    v_pk_mul_f32 v[104:105], v[46:47], v[96:97] op_sel:[0,0] op_sel_hi:[1,1]
    v_pk_mul_f32 v[96:97], v[44:45], v[96:97] op_sel:[0,0] op_sel_hi:[1,1]
    v_pk_fma_f32 v[96:97], v[46:47], v[98:99], v[96:97] op_sel:[0,0,0] op_sel_hi:[1,1,1] neg_lo:[1,0,0] neg_hi:[1,0,0]
    v_pk_fma_f32 v[98:99], v[44:45], v[98:99], v[104:105] op_sel:[0,0,0] op_sel_hi:[1,1,1]
    s_mov_b32 exec_lo, 0
    s_mov_b32 exec_hi, 0xffff0000
    v_pk_mul_f32 v[104:105], v[46:47], v[96:97] op_sel:[0,0] op_sel_hi:[1,1]
    v_pk_mul_f32 v[96:97], v[44:45], v[96:97] op_sel:[0,0] op_sel_hi:[1,1]
    v_pk_fma_f32 v[96:97], v[46:47], v[98:99], v[96:97] op_sel:[0,0,0] op_sel_hi:[1,1,1] neg_lo:[1,0,0] neg_hi:[1,0,0]
    v_pk_fma_f32 v[98:99], v[44:45], v[98:99], v[104:105] op_sel:[0,0,0] op_sel_hi:[1,1,1]
    s_mov_b64 exec, -1
    s_branch L_h1
L_h0:
    s_mov_b32 exec_lo, 0xffff0000
    s_mov_b32 exec_hi, -1
    s_waitcnt lgkmcnt(6)
    v_pk_fma_f32 v[100:101], v[46:47], v[92:93], v[66:67] op_sel:[0,0,0] op_sel_hi:[1,1,1]
    v_pk_fma_f32 v[92:93], v[44:45], v[92:93], v[64:65] op_sel:[0,0,0] op_sel_hi:[1,1,1]
    v_pk_fma_f32 v[92:93], v[46:47], v[94:95], v[92:93] op_sel:[0,0,0] op_sel_hi:[1,1,1] neg_lo:[1,0,0] neg_hi:[1,0,0]
    v_pk_fma_f32 v[94:95], v[44:45], v[94:95], v[100:101] op_sel:[0,0,0] op_sel_hi:[1,1,1]
    v_pk_mul_f32 v[104:105], v[46:47], v[96:97] op_sel:[0,0] op_sel_hi:[1,1]
    v_pk_mul_f32 v[96:97], v[44:45], v[96:97] op_sel:[0,0] op_sel_hi:[1,1]
    v_pk_fma_f32 v[96:97], v[46:47], v[98:99], v[96:97] op_sel:[0,0,0] op_sel_hi:[1,1,1] neg_lo:[1,0,0] neg_hi:[1,0,0]
    v_pk_fma_f32 v[98:99], v[44:45], v[98:99], v[104:105] op_sel:[0,0,0] op_sel_hi:[1,1,1]
    s_mov_b32 exec_lo, 0
    s_mov_b32 exec_hi, -1
    s_waitcnt lgkmcnt(5)
    v_pk_fma_f32 v[100:101], v[46:47], v[92:93], v[70:71] op_sel:[0,0,0] op_sel_hi:[1,1,1]
    v_pk_fma_f32 v[92:93], v[44:45], v[92:93], v[68:69] op_sel:[0,0,0] op_sel_hi:[1,1,1]
    v_pk_fma_f32 v[92:93], v[46:47], v[94:95], v[92:93] op_sel:[0,0,0] op_sel_hi:[1,1,1] neg_lo:[1,0,0] neg_hi:[1,0,0]
    v_pk_fma_f32 v[94:95], v[44:45], v[94:95], v[100:101] op_sel:[0,0,0] op_sel_hi:[1,1,1]
    v_pk_mul_f32 v[104:105], v[46:47], v[96:97] op_sel:[0,0] op_sel_hi:[1,1]
    v_pk_mul_f32 v[96:97], v[44:45], v[96:97] op_sel:[0,0] op_sel_hi:[1,1]
    v_pk_fma_f32 v[96:97], v[46:47], v[98:99], v[96:97] op_sel:[0,0,0] op_sel_hi:[1,1,1] neg_lo:[1,0,0] neg_hi:[1,0,0]
    v_pk_fma_f32 v[98:99], v[44:45], v[98:99], v[104:105] op_sel:[0,0,0] op_sel_hi:[1,1,1]
    s_mov_b32 exec_lo, 0
    s_mov_b32 exec_hi, 0xffff0000
    s_waitcnt lgkmcnt(4)
    v_pk_fma_f32 v[100:101], v[46:47], v[92:93], v[74:75] op_sel:[0,0,0] op_sel_hi:[1,1,1]
    v_pk_fma_f32 v[92:93], v[44:45], v[92:93], v[72:73] op_sel:[0,0,0] op_sel_hi:[1,1,1]
    v_pk_fma_f32 v[92:93], v[46:47], v[94:95], v[92:93] op_sel:[0,0,0] op_sel_hi:[1,1,1] neg_lo:[1,0,0] neg_hi:[1,0,0]
    v_pk_fma_f32 v[94:95], v[44:45], v[94:95], v[100:101] op_sel:[0,0,0] op_sel_hi:[1,1,1]
    v_pk_mul_f32 v[104:105], v[46:47], v[96:97] op_sel:[0,0] op_sel_hi:[1,1]
    v_pk_mul_f32 v[96:97], v[44:45], v[96:97] op_sel:[0,0] op_sel_hi:[1,1]
    v_pk_fma_f32 v[96:97], v[46:47], v[98:99], v[96:97] op_sel:[0,0,0] op_sel_hi:[1,1,1] neg_lo:[1,0,0] neg_hi:[1,0,0]
    v_pk_fma_f32 v[98:99], v[44:45], v[98:99], v[104:105] op_sel:[0,0,0] op_sel_hi:[1,1,1]
    s_mov_b64 exec, -1
L_h1:
    s_waitcnt lgkmcnt(0)
    v_pk_mul_f32 v[100:101], v[36:37], v[128:129] op_sel:[0,0] op_sel_hi:[0,1]
    v_pk_mul_f32 v[102:103], v[38:39], v[128:129] op_sel:[0,0] op_sel_hi:[0,1] neg_lo:[1,0] neg_hi:[1,0]
    v_pk_mul_f32 v[104:105], v[36:37], v[132:133] op_sel:[1,0] op_sel_hi:[1,1]
    v_pk_mul_f32 v[106:107], v[38:39], v[132:133] op_sel:[1,0] op_sel_hi:[1,1] neg_lo:[1,0] neg_hi:[1,0]
    v_pk_fma_f32 v[128:129], v[38:39], v[136:137], v[100:101] op_sel:[0,0,0] op_sel_hi:[0,1,1] neg_lo:[1,0,0] neg_hi:[1,0,0]
    v_pk_fma_f32 v[136:137], v[36:37], v[136:137], v[102:103] op_sel:[0,0,0] op_sel_hi:[0,1,1] neg_lo:[1,0,0] neg_hi:[1,0,0]
    v_pk_fma_f32 v[132:133], v[38:39], v[140:141], v[104:105] op_sel:[1,0,0] op_sel_hi:[1,1,1] neg_lo:[1,0,0] neg_hi:[1,0,0]
    v_pk_fma_f32 v[140:141], v[36:37], v[140:141], v[106:107] op_sel:[1,0,0] op_sel_hi:[1,1,1] neg_lo:[1,0,0] neg_hi:[1,0,0]
    v_pk_mul_f32 v[100:101], v[36:37], v[130:131] op_sel:[0,0] op_sel_hi:[0,1]
    v_pk_mul_f32 v[102:103], v[38:39], v[130:131] op_sel:[0,0] op_sel_hi:[0,1] neg_lo:[1,0] neg_hi:[1,0]
    v_pk_mul_f32 v[104:105], v[36:37], v[134:135] op_sel:[1,0] op_sel_hi:[1,1]
    v_pk_mul_f32 v[106:107], v[38:39], v[134:135] op_sel:[1,0] op_sel_hi:[1,1] neg_lo:[1,0] neg_hi:[1,0]
    v_pk_fma_f32 v[130:131], v[38:39], v[138:139], v[100:101] op_sel:[0,0,0] op_sel_hi:[0,1,1] neg_lo:[1,0,0] neg_hi:[1,0,0]
    v_pk_fma_f32 v[138:139], v[36:37], v[138:139], v[102:103] op_sel:[0,0,0] op_sel_hi:[0,1,1] neg_lo:[1,0,0] neg_hi:[1,0,0]
    v_pk_fma_f32 v[134:135], v[38:39], v[142:143], v[104:105] op_sel:[1,0,0] op_sel_hi:[1,1,1] neg_lo:[1,0,0] neg_hi:[1,0,0]
    v_pk_fma_f32 v[142:143], v[36:37], v[142:143], v[106:107] op_sel:[1,0,0] op_sel_hi:[1,1,1] neg_lo:[1,0,0] neg_hi:[1,0,0]
    v_pk_mul_f32 v[100:101], v[36:37], v[144:145] op_sel:[0,0] op_sel_hi:[0,1]
    v_pk_mul_f32 v[102:103], v[38:39], v[144:145] op_sel:[0,0] op_sel_hi:[0,1] neg_lo:[1,0] neg_hi:[1,0]
    v_pk_mul_f32 v[104:105], v[36:37], v[148:149] op_sel:[1,0] op_sel_hi:[1,1]
    v_pk_mul_f32 v[106:107], v[38:39], v[148:149] op_sel:[1,0] op_sel_hi:[1,1] neg_lo:[1,0] neg_hi:[1,0]
    v_pk_fma_f32 v[144:145], v[38:39], v[152:153], v[100:101] op_sel:[0,0,0] op_sel_hi:[0,1,1] neg_lo:[1,0,0] neg_hi:[1,0,0]
    v_pk_fma_f32 v[152:153], v[36:37], v[152:153], v[102:103] op_sel:[0,0,0] op_sel_hi:[0,1,1] neg_lo:[1,0,0] neg_hi:[1,0,0]
    v_pk_fma_f32 v[148:149], v[38:39], v[156:157], v[104:105] op_sel:[1,0,0] op_sel_hi:[1,1,1] neg_lo:[1,0,0] neg_hi:[1,0,0]
    v_pk_fma_f32 v[156:157], v[36:37], v[156:157], v[106:107] op_sel:[1,0,0] op_sel_hi:[1,1,1] neg_lo:[1,0,0] neg_hi:[1,0,0]
    v_pk_mul_f32 v[100:101], v[36:37], v[146:147] op_sel:[0,0] op_sel_hi:[0,1]
    v_pk_mul_f32 v[102:103], v[38:39], v[146:147] op_sel:[0,0] op_sel_hi:[0,1] neg_lo:[1,0] neg_hi:[1,0]
    v_pk_mul_f32 v[104:105], v[36:37], v[150:151] op_sel:[1,0] op_sel_hi:[1,1]
    v_pk_mul_f32 v[106:107], v[38:39], v[150:151] op_sel:[1,0] op_sel_hi:[1,1] neg_lo:[1,0] neg_hi:[1,0]
    v_pk_fma_f32 v[146:147], v[38:39], v[154:155], v[100:101] op_sel:[0,0,0] op_sel_hi:[0,1,1] neg_lo:[1,0,0] neg_hi:[1,0,0]
    v_pk_fma_f32 v[154:155], v[36:37], v[154:155], v[102:103] op_sel:[0,0,0] op_sel_hi:[0,1,1] neg_lo:[1,0,0] neg_hi:[1,0,0]
    v_pk_fma_f32 v[150:151], v[38:39], v[158:159], v[104:105] op_sel:[1,0,0] op_sel_hi:[1,1,1] neg_lo:[1,0,0] neg_hi:[1,0,0]
    v_pk_fma_f32 v[158:159], v[36:37], v[158:159], v[106:107] op_sel:[1,0,0] op_sel_hi:[1,1,1] neg_lo:[1,0,0] neg_hi:[1,0,0]
    v_pk_mul_f32 v[100:101], v[36:37], v[160:161] op_sel:[0,0] op_sel_hi:[0,1]
    v_pk_mul_f32 v[102:103], v[38:39], v[160:161] op_sel:[0,0] op_sel_hi:[0,1] neg_lo:[1,0] neg_hi:[1,0]
    v_pk_mul_f32 v[104:105], v[36:37], v[164:165] op_sel:[1,0] op_sel_hi:[1,1]
    v_pk_mul_f32 v[106:107], v[38:39], v[164:165] op_sel:[1,0] op_sel_hi:[1,1] neg_lo:[1,0] neg_hi:[1,0]
    v_pk_fma_f32 v[160:161], v[38:39], v[168:169], v[100:101] op_sel:[0,0,0] op_sel_hi:[0,1,1] neg_lo:[1,0,0] neg_hi:[1,0,0]
    v_pk_fma_f32 v[168:169], v[36:37], v[168:169], v[102:103] op_sel:[0,0,0] op_sel_hi:[0,1,1] neg_lo:[1,0,0] neg_hi:[1,0,0]
    v_pk_fma_f32 v[164:165], v[38:39], v[172:173], v[104:105] op_sel:[1,0,0] op_sel_hi:[1,1,1] neg_lo:[1,0,0] neg_hi:[1,0,0]
    v_pk_fma_f32 v[172:173], v[36:37], v[172:173], v[106:107] op_sel:[1,0,0] op_sel_hi:[1,1,1] neg_lo:[1,0,0] neg_hi:[1,0,0]
    v_pk_mul_f32 v[100:101], v[36:37], v[162:163] op_sel:[0,0] op_sel_hi:[0,1]
    v_pk_mul_f32 v[102:103], v[38:39], v[162:163] op_sel:[0,0] op_sel_hi:[0,1] neg_lo:[1,0] neg_hi:[1,0]
    v_pk_mul_f32 v[104:105], v[36:37], v[166:167] op_sel:[1,0] op_sel_hi:[1,1]
    v_pk_mul_f32 v[106:107], v[38:39], v[166:167] op_sel:[1,0] op_sel_hi:[1,1] neg_lo:[1,0] neg_hi:[1,0]
    v_pk_fma_f32 v[162:163], v[38:39], v[170:171], v[100:101] op_sel:[0,0,0] op_sel_hi:[0,1,1] neg_lo:[1,0,0] neg_hi:[1,0,0]
    v_pk_fma_f32 v[170:171], v[36:37], v[170:171], v[102:103] op_sel:[0,0,0] op_sel_hi:[0,1,1] neg_lo:[1,0,0] neg_hi:[1,0,0]
    v_pk_fma_f32 v[166:167], v[38:39], v[174:175], v[104:105] op_sel:[1,0,0] op_sel_hi:[1,1,1] neg_lo:[1,0,0] neg_hi:[1,0,0]
    v_pk_fma_f32 v[174:175], v[36:37], v[174:175], v[106:107] op_sel:[1,0,0] op_sel_hi:[1,1,1] neg_lo:[1,0,0] neg_hi:[1,0,0]
    v_pk_mul_f32 v[100:101], v[36:37], v[176:177] op_sel:[0,0] op_sel_hi:[0,1]
    v_pk_mul_f32 v[102:103], v[38:39], v[176:177] op_sel:[0,0] op_sel_hi:[0,1] neg_lo:[1,0] neg_hi:[1,0]
    v_pk_mul_f32 v[104:105], v[36:37], v[180:181] op_sel:[1,0] op_sel_hi:[1,1]
    v_pk_mul_f32 v[106:107], v[38:39], v[180:181] op_sel:[1,0] op_sel_hi:[1,1] neg_lo:[1,0] neg_hi:[1,0]
    v_pk_fma_f32 v[176:177], v[38:39], v[184:185], v[100:101] op_sel:[0,0,0] op_sel_hi:[0,1,1] neg_lo:[1,0,0] neg_hi:[1,0,0]
    v_pk_fma_f32 v[184:185], v[36:37], v[184:185], v[102:103] op_sel:[0,0,0] op_sel_hi:[0,1,1] neg_lo:[1,0,0] neg_hi:[1,0,0]
    v_pk_fma_f32 v[180:181], v[38:39], v[188:189], v[104:105] op_sel:[1,0,0] op_sel_hi:[1,1,1] neg_lo:[1,0,0] neg_hi:[1,0,0]
    v_pk_fma_f32 v[188:189], v[36:37], v[188:189], v[106:107] op_sel:[1,0,0] op_sel_hi:[1,1,1] neg_lo:[1,0,0] neg_hi:[1,0,0]
    v_pk_mul_f32 v[100:101], v[36:37], v[178:179] op_sel:[0,0] op_sel_hi:[0,1]
    v_pk_mul_f32 v[102:103], v[38:39], v[178:179] op_sel:[0,0] op_sel_hi:[0,1] neg_lo:[1,0] neg_hi:[1,0]
    v_pk_mul_f32 v[104:105], v[36:37], v[182:183] op_sel:[1,0] op_sel_hi:[1,1]
    v_pk_mul_f32 v[106:107], v[38:39], v[182:183] op_sel:[1,0] op_sel_hi:[1,1] neg_lo:[1,0] neg_hi:[1,0]
    v_pk_fma_f32 v[178:179], v[38:39], v[186:187], v[100:101] op_sel:[0,0,0] op_sel_hi:[0,1,1] neg_lo:[1,0,0] neg_hi:[1,0,0]
    v_pk_fma_f32 v[186:187], v[36:37], v[186:187], v[102:103] op_sel:[0,0,0] op_sel_hi:[0,1,1] neg_lo:[1,0,0] neg_hi:[1,0,0]
    v_pk_fma_f32 v[182:183], v[38:39], v[190:191], v[104:105] op_sel:[1,0,0] op_sel_hi:[1,1,1] neg_lo:[1,0,0] neg_hi:[1,0,0]
    v_pk_fma_f32 v[190:191], v[36:37], v[190:191], v[106:107] op_sel:[1,0,0] op_sel_hi:[1,1,1] neg_lo:[1,0,0] neg_hi:[1,0,0]
    v_pk_mul_f32 v[100:101], v[36:37], v[192:193] op_sel:[0,0] op_sel_hi:[0,1]
    v_pk_mul_f32 v[102:103], v[38:39], v[192:193] op_sel:[0,0] op_sel_hi:[0,1] neg_lo:[1,0] neg_hi:[1,0]
    v_pk_mul_f32 v[104:105], v[36:37], v[196:197] op_sel:[1,0] op_sel_hi:[1,1]
    v_pk_mul_f32 v[106:107], v[38:39], v[196:197] op_sel:[1,0] op_sel_hi:[1,1] neg_lo:[1,0] neg_hi:[1,0]
    v_pk_fma_f32 v[192:193], v[38:39], v[200:201], v[100:101] op_sel:[0,0,0] op_sel_hi:[0,1,1] neg_lo:[1,0,0] neg_hi:[1,0,0]
    v_pk_fma_f32 v[200:201], v[36:37], v[200:201], v[102:103] op_sel:[0,0,0] op_sel_hi:[0,1,1] neg_lo:[1,0,0] neg_hi:[1,0,0]
    v_pk_fma_f32 v[196:197], v[38:39], v[204:205], v[104:105] op_sel:[1,0,0] op_sel_hi:[1,1,1] neg_lo:[1,0,0] neg_hi:[1,0,0]
    v_pk_fma_f32 v[204:205], v[36:37], v[204:205], v[106:107] op_sel:[1,0,0] op_sel_hi:[1,1,1] neg_lo:[1,0,0] neg_hi:[1,0,0]
    v_pk_mul_f32 v[100:101], v[36:37], v[194:195] op_sel:[0,0] op_sel_hi:[0,1]
    v_pk_mul_f32 v[102:103], v[38:39], v[194:195] op_sel:[0,0] op_sel_hi:[0,1] neg_lo:[1,0] neg_hi:[1,0]
    v_pk_mul_f32 v[104:105], v[36:37], v[198:199] op_sel:[1,0] op_sel_hi:[1,1]
    v_pk_mul_f32 v[106:107], v[38:39], v[198:199] op_sel:[1,0] op_sel_hi:[1,1] neg_lo:[1,0] neg_hi:[1,0]
    v_pk_fma_f32 v[194:195], v[38:39], v[202:203], v[100:101] op_sel:[0,0,0] op_sel_hi:[0,1,1] neg_lo:[1,0,0] neg_hi:[1,0,0]
    v_pk_fma_f32 v[202:203], v[36:37], v[202:203], v[102:103] op_sel:[0,0,0] op_sel_hi:[0,1,1] neg_lo:[1,0,0] neg_hi:[1,0,0]
    v_pk_fma_f32 v[198:199], v[38:39], v[206:207], v[104:105] op_sel:[1,0,0] op_sel_hi:[1,1,1] neg_lo:[1,0,0] neg_hi:[1,0,0]
    v_pk_fma_f32 v[206:207], v[36:37], v[206:207], v[106:107] op_sel:[1,0,0] op_sel_hi:[1,1,1] neg_lo:[1,0,0] neg_hi:[1,0,0]
    v_pk_mul_f32 v[100:101], v[36:37], v[208:209] op_sel:[0,0] op_sel_hi:[0,1]
    v_pk_mul_f32 v[102:103], v[38:39], v[208:209] op_sel:[0,0] op_sel_hi:[0,1] neg_lo:[1,0] neg_hi:[1,0]
    v_pk_mul_f32 v[104:105], v[36:37], v[212:213] op_sel:[1,0] op_sel_hi:[1,1]
    v_pk_mul_f32 v[106:107], v[38:39], v[212:213] op_sel:[1,0] op_sel_hi:[1,1] neg_lo:[1,0] neg_hi:[1,0]
    v_pk_fma_f32 v[208:209], v[38:39], v[216:217], v[100:101] op_sel:[0,0,0] op_sel_hi:[0,1,1] neg_lo:[1,0,0] neg_hi:[1,0,0]
    v_pk_fma_f32 v[216:217], v[36:37], v[216:217], v[102:103] op_sel:[0,0,0] op_sel_hi:[0,1,1] neg_lo:[1,0,0] neg_hi:[1,0,0]
    v_pk_fma_f32 v[212:213], v[38:39], v[220:221], v[104:105] op_sel:[1,0,0] op_sel_hi:[1,1,1] neg_lo:[1,0,0] neg_hi:[1,0,0]
    v_pk_fma_f32 v[220:221], v[36:37], v[220:221], v[106:107] op_sel:[1,0,0] op_sel_hi:[1,1,1] neg_lo:[1,0,0] neg_hi:[1,0,0]
    v_pk_mul_f32 v[100:101], v[36:37], v[210:211] op_sel:[0,0] op_sel_hi:[0,1]
    v_pk_mul_f32 v[102:103], v[38:39], v[210:211] op_sel:[0,0] op_sel_hi:[0,1] neg_lo:[1,0] neg_hi:[1,0]
    v_pk_mul_f32 v[104:105], v[36:37], v[214:215] op_sel:[1,0] op_sel_hi:[1,1]
    v_pk_mul_f32 v[106:107], v[38:39], v[214:215] op_sel:[1,0] op_sel_hi:[1,1] neg_lo:[1,0] neg_hi:[1,0]
    v_pk_fma_f32 v[210:211], v[38:39], v[218:219], v[100:101] op_sel:[0,0,0] op_sel_hi:[0,1,1] neg_lo:[1,0,0] neg_hi:[1,0,0]
    v_pk_fma_f32 v[218:219], v[36:37], v[218:219], v[102:103] op_sel:[0,0,0] op_sel_hi:[0,1,1] neg_lo:[1,0,0] neg_hi:[1,0,0]
    v_pk_fma_f32 v[214:215], v[38:39], v[222:223], v[104:105] op_sel:[1,0,0] op_sel_hi:[1,1,1] neg_lo:[1,0,0] neg_hi:[1,0,0]
    v_pk_fma_f32 v[222:223], v[36:37], v[222:223], v[106:107] op_sel:[1,0,0] op_sel_hi:[1,1,1] neg_lo:[1,0,0] neg_hi:[1,0,0]
    v_pk_mul_f32 v[100:101], v[36:37], v[224:225] op_sel:[0,0] op_sel_hi:[0,1]
    v_pk_mul_f32 v[102:103], v[38:39], v[224:225] op_sel:[0,0] op_sel_hi:[0,1] neg_lo:[1,0] neg_hi:[1,0]
    v_pk_mul_f32 v[104:105], v[36:37], v[228:229] op_sel:[1,0] op_sel_hi:[1,1]
    v_pk_mul_f32 v[106:107], v[38:39], v[228:229] op_sel:[1,0] op_sel_hi:[1,1] neg_lo:[1,0] neg_hi:[1,0]
    v_pk_fma_f32 v[224:225], v[38:39], v[232:233], v[100:101] op_sel:[0,0,0] op_sel_hi:[0,1,1] neg_lo:[1,0,0] neg_hi:[1,0,0]
    v_pk_fma_f32 v[232:233], v[36:37], v[232:233], v[102:103] op_sel:[0,0,0] op_sel_hi:[0,1,1] neg_lo:[1,0,0] neg_hi:[1,0,0]
    v_pk_fma_f32 v[228:229], v[38:39], v[236:237], v[104:105] op_sel:[1,0,0] op_sel_hi:[1,1,1] neg_lo:[1,0,0] neg_hi:[1,0,0]
    v_pk_fma_f32 v[236:237], v[36:37], v[236:237], v[106:107] op_sel:[1,0,0] op_sel_hi:[1,1,1] neg_lo:[1,0,0] neg_hi:[1,0,0]
    v_pk_mul_f32 v[100:101], v[36:37], v[226:227] op_sel:[0,0] op_sel_hi:[0,1]
    v_pk_mul_f32 v[102:103], v[38:39], v[226:227] op_sel:[0,0] op_sel_hi:[0,1] neg_lo:[1,0] neg_hi:[1,0]
    v_pk_mul_f32 v[104:105], v[36:37], v[230:231] op_sel:[1,0] op_sel_hi:[1,1]
    v_pk_mul_f32 v[106:107], v[38:39], v[230:231] op_sel:[1,0] op_sel_hi:[1,1] neg_lo:[1,0] neg_hi:[1,0]
    v_pk_fma_f32 v[226:227], v[38:39], v[234:235], v[100:101] op_sel:[0,0,0] op_sel_hi:[0,1,1] neg_lo:[1,0,0] neg_hi:[1,0,0]
    v_pk_fma_f32 v[234:235], v[36:37], v[234:235], v[102:103] op_sel:[0,0,0] op_sel_hi:[0,1,1] neg_lo:[1,0,0] neg_hi:[1,0,0]
    v_pk_fma_f32 v[230:231], v[38:39], v[238:239], v[104:105] op_sel:[1,0,0] op_sel_hi:[1,1,1] neg_lo:[1,0,0] neg_hi:[1,0,0]
    v_pk_fma_f32 v[238:239], v[36:37], v[238:239], v[106:107] op_sel:[1,0,0] op_sel_hi:[1,1,1] neg_lo:[1,0,0] neg_hi:[1,0,0]
    v_pk_mul_f32 v[100:101], v[36:37], v[240:241] op_sel:[0,0] op_sel_hi:[0,1]
    v_pk_mul_f32 v[102:103], v[38:39], v[240:241] op_sel:[0,0] op_sel_hi:[0,1] neg_lo:[1,0] neg_hi:[1,0]
    v_pk_mul_f32 v[104:105], v[36:37], v[244:245] op_sel:[1,0] op_sel_hi:[1,1]
    v_pk_mul_f32 v[106:107], v[38:39], v[244:245] op_sel:[1,0] op_sel_hi:[1,1] neg_lo:[1,0] neg_hi:[1,0]
    v_pk_fma_f32 v[240:241], v[38:39], v[248:249], v[100:101] op_sel:[0,0,0] op_sel_hi:[0,1,1] neg_lo:[1,0,0] neg_hi:[1,0,0]
    v_pk_fma_f32 v[248:249], v[36:37], v[248:249], v[102:103] op_sel:[0,0,0] op_sel_hi:[0,1,1] neg_lo:[1,0,0] neg_hi:[1,0,0]
    v_pk_fma_f32 v[244:245], v[38:39], v[252:253], v[104:105] op_sel:[1,0,0] op_sel_hi:[1,1,1] neg_lo:[1,0,0] neg_hi:[1,0,0]
    v_pk_fma_f32 v[252:253], v[36:37], v[252:253], v[106:107] op_sel:[1,0,0] op_sel_hi:[1,1,1] neg_lo:[1,0,0] neg_hi:[1,0,0]
    v_pk_mul_f32 v[100:101], v[36:37], v[242:243] op_sel:[0,0] op_sel_hi:[0,1]
    v_pk_mul_f32 v[102:103], v[38:39], v[242:243] op_sel:[0,0] op_sel_hi:[0,1] neg_lo:[1,0] neg_hi:[1,0]
    v_pk_mul_f32 v[104:105], v[36:37], v[246:247] op_sel:[1,0] op_sel_hi:[1,1]
    v_pk_mul_f32 v[106:107], v[38:39], v[246:247] op_sel:[1,0] op_sel_hi:[1,1] neg_lo:[1,0] neg_hi:[1,0]
    v_pk_fma_f32 v[242:243], v[38:39], v[250:251], v[100:101] op_sel:[0,0,0] op_sel_hi:[0,1,1] neg_lo:[1,0,0] neg_hi:[1,0,0]
    v_pk_fma_f32 v[250:251], v[36:37], v[250:251], v[102:103] op_sel:[0,0,0] op_sel_hi:[0,1,1] neg_lo:[1,0,0] neg_hi:[1,0,0]
    v_pk_fma_f32 v[246:247], v[38:39], v[254:255], v[104:105] op_sel:[1,0,0] op_sel_hi:[1,1,1] neg_lo:[1,0,0] neg_hi:[1,0,0]
    v_pk_fma_f32 v[254:255], v[36:37], v[254:255], v[106:107] op_sel:[1,0,0] op_sel_hi:[1,1,1] neg_lo:[1,0,0] neg_hi:[1,0,0]
    v_mov_b32 v8, v92
    v_mov_b32 v9, v93
    v_mov_b32 v10, v94
    v_mov_b32 v11, v95
    v_mov_b32 v12, v96
    v_mov_b32 v13, v97
    v_mov_b32 v14, v98
    v_mov_b32 v15, v99
    v_pk_mul_f32 v[66:67], v[38:39], v[32:33] op_sel:[0,0] op_sel_hi:[1,1]
    v_pk_mul_f32 v[64:65], v[36:37], v[32:33] op_sel:[0,0] op_sel_hi:[1,1]
    v_pk_fma_f32 v[64:65], v[38:39], v[34:35], v[64:65] op_sel:[0,0,0] op_sel_hi:[1,1,1] neg_lo:[1,0,0] neg_hi:[1,0,0]
    v_pk_fma_f32 v[66:67], v[36:37], v[34:35], v[66:67] op_sel:[0,0,0] op_sel_hi:[1,1,1]
    v_pk_mul_f32 v[70:71], v[66:67], v[32:33] op_sel:[0,0] op_sel_hi:[1,1]
    v_pk_mul_f32 v[68:69], v[64:65], v[32:33] op_sel:[0,0] op_sel_hi:[1,1]
    v_pk_fma_f32 v[68:69], v[66:67], v[34:35], v[68:69] op_sel:[0,0,0] op_sel_hi:[1,1,1] neg_lo:[1,0,0] neg_hi:[1,0,0]
    v_pk_fma_f32 v[70:71], v[64:65], v[34:35], v[70:71] op_sel:[0,0,0] op_sel_hi:[1,1,1]
    v_pk_mul_f32 v[74:75], v[70:71], v[32:33] op_sel:[0,0] op_sel_hi:[1,1]
    v_pk_mul_f32 v[72:73], v[68:69], v[32:33] op_sel:[0,0] op_sel_hi:[1,1]
    v_pk_fma_f32 v[72:73], v[70:71], v[34:35], v[72:73] op_sel:[0,0,0] op_sel_hi:[1,1,1] neg_lo:[1,0,0] neg_hi:[1,0,0]
    v_pk_fma_f32 v[74:75], v[68:69], v[34:35], v[74:75] op_sel:[0,0,0] op_sel_hi:[1,1,1]
    v_pk_mul_f32 v[78:79], v[74:75], v[32:33] op_sel:[0,0] op_sel_hi:[1,1]
    v_pk_mul_f32 v[76:77], v[72:73], v[32:33] op_sel:[0,0] op_sel_hi:[1,1]
    v_pk_fma_f32 v[76:77], v[74:75], v[34:35], v[76:77] op_sel:[0,0,0] op_sel_hi:[1,1,1] neg_lo:[1,0,0] neg_hi:[1,0,0]
    v_pk_fma_f32 v[78:79], v[72:73], v[34:35], v[78:79] op_sel:[0,0,0] op_sel_hi:[1,1,1]
    v_pk_mul_f32 v[82:83], v[78:79], v[32:33] op_sel:[0,0] op_sel_hi:[1,1]
    v_pk_mul_f32 v[80:81], v[76:77], v[32:33] op_sel:[0,0] op_sel_hi:[1,1]
    v_pk_fma_f32 v[80:81], v[78:79], v[34:35], v[80:81] op_sel:[0,0,0] op_sel_hi:[1,1,1] neg_lo:[1,0,0] neg_hi:[1,0,0]
    v_pk_fma_f32 v[82:83], v[76:77], v[34:35], v[82:83] op_sel:[0,0,0] op_sel_hi:[1,1,1]
    v_pk_mul_f32 v[86:87], v[82:83], v[32:33] op_sel:[0,0] op_sel_hi:[1,1]
    v_pk_mul_f32 v[84:85], v[80:81], v[32:33] op_sel:[0,0] op_sel_hi:[1,1]
    v_pk_fma_f32 v[84:85], v[82:83], v[34:35], v[84:85] op_sel:[0,0,0] op_sel_hi:[1,1,1] neg_lo:[1,0,0] neg_hi:[1,0,0]
    v_pk_fma_f32 v[86:87], v[80:81], v[34:35], v[86:87] op_sel:[0,0,0] op_sel_hi:[1,1,1]
    v_pk_mul_f32 v[90:91], v[86:87], v[32:33] op_sel:[0,0] op_sel_hi:[1,1]
    v_pk_mul_f32 v[88:89], v[84:85], v[32:33] op_sel:[0,0] op_sel_hi:[1,1]
    v_pk_fma_f32 v[88:89], v[86:87], v[34:35], v[88:89] op_sel:[0,0,0] op_sel_hi:[1,1,1] neg_lo:[1,0,0] neg_hi:[1,0,0]
    v_pk_fma_f32 v[90:91], v[84:85], v[34:35], v[90:91] op_sel:[0,0,0] op_sel_hi:[1,1,1]
    v_pk_mul_f32 v[94:95], v[90:91], v[32:33] op_sel:[0,0] op_sel_hi:[1,1]
    v_pk_mul_f32 v[92:93], v[88:89], v[32:33] op_sel:[0,0] op_sel_hi:[1,1]
    v_pk_fma_f32 v[92:93], v[90:91], v[34:35], v[92:93] op_sel:[0,0,0] op_sel_hi:[1,1,1] neg_lo:[1,0,0] neg_hi:[1,0,0]
    v_pk_fma_f32 v[94:95], v[88:89], v[34:35], v[94:95] op_sel:[0,0,0] op_sel_hi:[1,1,1]
    v_pk_mul_f32 v[98:99], v[94:95], v[32:33] op_sel:[0,0] op_sel_hi:[1,1]
    v_pk_mul_f32 v[96:97], v[92:93], v[32:33] op_sel:[0,0] op_sel_hi:[1,1]
    v_pk_fma_f32 v[96:97], v[94:95], v[34:35], v[96:97] op_sel:[0,0,0] op_sel_hi:[1,1,1] neg_lo:[1,0,0] neg_hi:[1,0,0]
    v_pk_fma_f32 v[98:99], v[92:93], v[34:35], v[98:99] op_sel:[0,0,0] op_sel_hi:[1,1,1]
    v_pk_mul_f32 v[102:103], v[98:99], v[32:33] op_sel:[0,0] op_sel_hi:[1,1]
    v_pk_mul_f32 v[100:101], v[96:97], v[32:33] op_sel:[0,0] op_sel_hi:[1,1]
    v_pk_fma_f32 v[100:101], v[98:99], v[34:35], v[100:101] op_sel:[0,0,0] op_sel_hi:[1,1,1] neg_lo:[1,0,0] neg_hi:[1,0,0]
    v_pk_fma_f32 v[102:103], v[96:97], v[34:35], v[102:103] op_sel:[0,0,0] op_sel_hi:[1,1,1]
    v_pk_mul_f32 v[106:107], v[102:103], v[32:33] op_sel:[0,0] op_sel_hi:[1,1]
    v_pk_mul_f32 v[104:105], v[100:101], v[32:33] op_sel:[0,0] op_sel_hi:[1,1]
    v_pk_fma_f32 v[104:105], v[102:103], v[34:35], v[104:105] op_sel:[0,0,0] op_sel_hi:[1,1,1] neg_lo:[1,0,0] neg_hi:[1,0,0]
    v_pk_fma_f32 v[106:107], v[100:101], v[34:35], v[106:107] op_sel:[0,0,0] op_sel_hi:[1,1,1]
    v_pk_mul_f32 v[110:111], v[106:107], v[32:33] op_sel:[0,0] op_sel_hi:[1,1]
    v_pk_mul_f32 v[108:109], v[104:105], v[32:33] op_sel:[0,0] op_sel_hi:[1,1]
    v_pk_fma_f32 v[108:109], v[106:107], v[34:35], v[108:109] op_sel:[0,0,0] op_sel_hi:[1,1,1] neg_lo:[1,0,0] neg_hi:[1,0,0]
    v_pk_fma_f32 v[110:111], v[104:105], v[34:35], v[110:111] op_sel:[0,0,0] op_sel_hi:[1,1,1]
    v_pk_mul_f32 v[114:115], v[110:111], v[32:33] op_sel:[0,0] op_sel_hi:[1,1]
    v_pk_mul_f32 v[112:113], v[108:109], v[32:33] op_sel:[0,0] op_sel_hi:[1,1]
    v_pk_fma_f32 v[112:113], v[110:111], v[34:35], v[112:113] op_sel:[0,0,0] op_sel_hi:[1,1,1] neg_lo:[1,0,0] neg_hi:[1,0,0]
    v_pk_fma_f32 v[114:115], v[108:109], v[34:35], v[114:115] op_sel:[0,0,0] op_sel_hi:[1,1,1]
    v_pk_mul_f32 v[118:119], v[114:115], v[32:33] op_sel:[0,0] op_sel_hi:[1,1]
    v_pk_mul_f32 v[116:117], v[112:113], v[32:33] op_sel:[0,0] op_sel_hi:[1,1]
    v_pk_fma_f32 v[116:117], v[114:115], v[34:35], v[116:117] op_sel:[0,0,0] op_sel_hi:[1,1,1] neg_lo:[1,0,0] neg_hi:[1,0,0]
    v_pk_fma_f32 v[118:119], v[112:113], v[34:35], v[118:119] op_sel:[0,0,0] op_sel_hi:[1,1,1]
    v_pk_mul_f32 v[122:123], v[118:119], v[32:33] op_sel:[0,0] op_sel_hi:[1,1]
    v_pk_mul_f32 v[120:121], v[116:117], v[32:33] op_sel:[0,0] op_sel_hi:[1,1]
    v_pk_fma_f32 v[120:121], v[118:119], v[34:35], v[120:121] op_sel:[0,0,0] op_sel_hi:[1,1,1] neg_lo:[1,0,0] neg_hi:[1,0,0]
    v_pk_fma_f32 v[122:123], v[116:117], v[34:35], v[122:123] op_sel:[0,0,0] op_sel_hi:[1,1,1]
    v_pk_mul_f32 v[126:127], v[122:123], v[32:33] op_sel:[0,0] op_sel_hi:[1,1]
    v_pk_mul_f32 v[124:125], v[120:121], v[32:33] op_sel:[0,0] op_sel_hi:[1,1]
    v_pk_fma_f32 v[124:125], v[122:123], v[34:35], v[124:125] op_sel:[0,0,0] op_sel_hi:[1,1,1] neg_lo:[1,0,0] neg_hi:[1,0,0]
    v_pk_fma_f32 v[126:127], v[120:121], v[34:35], v[126:127] op_sel:[0,0,0] op_sel_hi:[1,1,1]
    v_mov_b32 v16, 0
    v_mov_b32 v17, 0
    v_mov_b32 v18, 0
    v_mov_b32 v19, 0
    s_cmp_eq_u32 s40, 0
    s_cbranch_scc1 L_nocarry
    s_lshl_b32 s48, s41, 13
    s_lshl_b32 s49, s47, 8
    s_add_u32 s48, s48, s49
    s_add_u32 s48, s48, 16777216
    v_lshlrev_b32 v5, 4, v1
    v_mov_b32 v28, v5
    s_mov_b32 s50, 131072
L_poll:
    s_min_u32 s49, s40, 1
    s_sub_u32 s49, s49, 1
    s_lshl_b32 s49, s49, 10
    s_add_u32 s49, s49, s48
    buffer_load_dwordx4 v[20:23], v28, s[20:23], s49 offen sc1
    s_min_u32 s49, s40, 2
    s_sub_u32 s49, s49, 1
    s_lshl_b32 s49, s49, 10
    s_add_u32 s49, s49, s48
    buffer_load_dwordx4 v[24:27], v28, s[20:23], s49 offen sc1
    s_min_u32 s49, s40, 3
    s_sub_u32 s49, s49, 1
    s_lshl_b32 s49, s49, 10
    s_add_u32 s49, s49, s48
    buffer_load_dwordx4 v[4:7], v28, s[20:23], s49 offen sc1
    s_min_u32 s49, s40, 4
    s_sub_u32 s49, s49, 1
    s_lshl_b32 s49, s49, 10
    s_add_u32 s49, s49, s48
    buffer_load_dwordx4 v[56:59], v28, s[20:23], s49 offen sc1
    s_min_u32 s49, s40, 5
    s_sub_u32 s49, s49, 1
    s_lshl_b32 s49, s49, 10
    s_add_u32 s49, s49, s48
    buffer_load_dwordx4 v[60:63], v28, s[20:23], s49 offen sc1
    s_min_u32 s49, s40, 6
    s_sub_u32 s49, s49, 1
    s_lshl_b32 s49, s49, 10
    s_add_u32 s49, s49, s48
    buffer_load_dwordx4 v[32:35], v28, s[20:23], s49 offen sc1
    s_min_u32 s49, s40, 7
    s_sub_u32 s49, s49, 1
    s_lshl_b32 s49, s49, 10
    s_add_u32 s49, s49, s48
    buffer_load_dwordx4 v[36:39], v28, s[20:23], s49 offen sc1
    s_waitcnt vmcnt(6)
    v_max_u32 v2, v20, v21
    v_max3_u32 v2, v22, v23, v2
    s_waitcnt vmcnt(5)
    v_max3_u32 v2, v24, v25, v2
    v_max3_u32 v2, v26, v27, v2
    s_waitcnt vmcnt(4)
    v_max3_u32 v2, v4, v5, v2
    v_max3_u32 v2, v6, v7, v2
    s_waitcnt vmcnt(3)
    v_max3_u32 v2, v56, v57, v2
    v_max3_u32 v2, v58, v59, v2
    s_waitcnt vmcnt(2)
    v_max3_u32 v2, v60, v61, v2
    v_max3_u32 v2, v62, v63, v2
    s_waitcnt vmcnt(1)
    v_max3_u32 v2, v32, v33, v2
    v_max3_u32 v2, v34, v35, v2
    s_waitcnt vmcnt(0)
    v_max3_u32 v2, v36, v37, v2
    v_max3_u32 v2, v38, v39, v2
    v_cmp_eq_u32 vcc, -1, v2
    s_cbranch_vccz L_polled
    s_sub_u32 s50, s50, 1
    s_cmp_eq_u32 s50, 0
    s_cbranch_scc1 L_polled
    s_branch L_poll
L_polled:
    s_cmp_le_u32 s40, 0
    s_cbranch_scc1 L_nocarry
    v_pk_fma_f32 v[2:3], v[50:51], v[16:17], v[22:23] op_sel:[0,0,0] op_sel_hi:[1,1,1]
    v_pk_fma_f32 v[16:17], v[48:49], v[16:17], v[20:21] op_sel:[0,0,0] op_sel_hi:[1,1,1]
    v_pk_fma_f32 v[16:17], v[50:51], v[18:19], v[16:17] op_sel:[0,0,0] op_sel_hi:[1,1,1] neg_lo:[1,0,0] neg_hi:[1,0,0]
    v_pk_fma_f32 v[18:19], v[48:49], v[18:19], v[2:3] op_sel:[0,0,0] op_sel_hi:[1,1,1]
    s_cmp_le_u32 s40, 1
    s_cbranch_scc1 L_nocarry
    v_pk_fma_f32 v[2:3], v[50:51], v[16:17], v[26:27] op_sel:[0,0,0] op_sel_hi:[1,1,1]
    v_pk_fma_f32 v[16:17], v[48:49], v[16:17], v[24:25] op_sel:[0,0,0] op_sel_hi:[1,1,1]
    v_pk_fma_f32 v[16:17], v[50:51], v[18:19], v[16:17] op_sel:[0,0,0] op_sel_hi:[1,1,1] neg_lo:[1,0,0] neg_hi:[1,0,0]
    v_pk_fma_f32 v[18:19], v[48:49], v[18:19], v[2:3] op_sel:[0,0,0] op_sel_hi:[1,1,1]
    s_cmp_le_u32 s40, 2
    s_cbranch_scc1 L_nocarry
    v_pk_fma_f32 v[2:3], v[50:51], v[16:17], v[6:7] op_sel:[0,0,0] op_sel_hi:[1,1,1]
    v_pk_fma_f32 v[16:17], v[48:49], v[16:17], v[4:5] op_sel:[0,0,0] op_sel_hi:[1,1,1]
    v_pk_fma_f32 v[16:17], v[50:51], v[18:19], v[16:17] op_sel:[0,0,0] op_sel_hi:[1,1,1] neg_lo:[1,0,0] neg_hi:[1,0,0]
    v_pk_fma_f32 v[18:19], v[48:49], v[18:19], v[2:3] op_sel:[0,0,0] op_sel_hi:[1,1,1]
    s_cmp_le_u32 s40, 3
    s_cbranch_scc1 L_nocarry
    v_pk_fma_f32 v[2:3], v[50:51], v[16:17], v[58:59] op_sel:[0,0,0] op_sel_hi:[1,1,1]
    v_pk_fma_f32 v[16:17], v[48:49], v[16:17], v[56:57] op_sel:[0,0,0] op_sel_hi:[1,1,1]
    v_pk_fma_f32 v[16:17], v[50:51], v[18:19], v[16:17] op_sel:[0,0,0] op_sel_hi:[1,1,1] neg_lo:[1,0,0] neg_hi:[1,0,0]
    v_pk_fma_f32 v[18:19], v[48:49], v[18:19], v[2:3] op_sel:[0,0,0] op_sel_hi:[1,1,1]
    s_cmp_le_u32 s40, 4
    s_cbranch_scc1 L_nocarry
    v_pk_fma_f32 v[2:3], v[50:51], v[16:17], v[62:63] op_sel:[0,0,0] op_sel_hi:[1,1,1]
    v_pk_fma_f32 v[16:17], v[48:49], v[16:17], v[60:61] op_sel:[0,0,0] op_sel_hi:[1,1,1]
    v_pk_fma_f32 v[16:17], v[50:51], v[18:19], v[16:17] op_sel:[0,0,0] op_sel_hi:[1,1,1] neg_lo:[1,0,0] neg_hi:[1,0,0]
    v_pk_fma_f32 v[18:19], v[48:49], v[18:19], v[2:3] op_sel:[0,0,0] op_sel_hi:[1,1,1]
    s_cmp_le_u32 s40, 5
    s_cbranch_scc1 L_nocarry
    v_pk_fma_f32 v[2:3], v[50:51], v[16:17], v[34:35] op_sel:[0,0,0] op_sel_hi:[1,1,1]
    v_pk_fma_f32 v[16:17], v[48:49], v[16:17], v[32:33] op_sel:[0,0,0] op_sel_hi:[1,1,1]
    v_pk_fma_f32 v[16:17], v[50:51], v[18:19], v[16:17] op_sel:[0,0,0] op_sel_hi:[1,1,1] neg_lo:[1,0,0] neg_hi:[1,0,0]
    v_pk_fma_f32 v[18:19], v[48:49], v[18:19], v[2:3] op_sel:[0,0,0] op_sel_hi:[1,1,1]
    s_cmp_le_u32 s40, 6
    s_cbranch_scc1 L_nocarry
    v_pk_fma_f32 v[2:3], v[50:51], v[16:17], v[38:39] op_sel:[0,0,0] op_sel_hi:[1,1,1]
    v_pk_fma_f32 v[16:17], v[48:49], v[16:17], v[36:37] op_sel:[0,0,0] op_sel_hi:[1,1,1]
    v_pk_fma_f32 v[16:17], v[50:51], v[18:19], v[16:17] op_sel:[0,0,0] op_sel_hi:[1,1,1] neg_lo:[1,0,0] neg_hi:[1,0,0]
    v_pk_fma_f32 v[18:19], v[48:49], v[18:19], v[2:3] op_sel:[0,0,0] op_sel_hi:[1,1,1]
L_nocarry:
    v_pk_fma_f32 v[22:23], v[14:15], v[16:17], v[10:11] op_sel:[0,0,0] op_sel_hi:[1,1,1]
    v_pk_fma_f32 v[20:21], v[12:13], v[16:17], v[8:9] op_sel:[0,0,0] op_sel_hi:[1,1,1]
    v_pk_fma_f32 v[20:21], v[14:15], v[18:19], v[20:21] op_sel:[0,0,0] op_sel_hi:[1,1,1] neg_lo:[1,0,0] neg_hi:[1,0,0]
    v_pk_fma_f32 v[22:23], v[12:13], v[18:19], v[22:23] op_sel:[0,0,0] op_sel_hi:[1,1,1]
    v_pk_fma_f32 v[26:27], v[42:43], v[20:21], v[54:55] op_sel:[0,0,0] op_sel_hi:[1,1,1]
    v_pk_fma_f32 v[24:25], v[40:41], v[20:21], v[52:53] op_sel:[0,0,0] op_sel_hi:[1,1,1]
    v_pk_fma_f32 v[24:25], v[42:43], v[22:23], v[24:25] op_sel:[0,0,0] op_sel_hi:[1,1,1] neg_lo:[1,0,0] neg_hi:[1,0,0]
    v_pk_fma_f32 v[26:27], v[40:41], v[22:23], v[26:27] op_sel:[0,0,0] op_sel_hi:[1,1,1]
    v_mov_b32 v56, v20
    v_mov_b32 v57, v24
    v_mov_b32 v60, v22
    v_mov_b32 v61, v26
    v_mov_b32 v58, v21
    v_mov_b32 v59, v25
    v_mov_b32 v62, v23
    v_mov_b32 v63, v27
    s_lshl_b32 s48, s47, 5
    v_add_u32 v2, s48, v1
    s_mov_b32 s49, 528
    v_mul_lo_u32 v2, v2, s49
    v_lshrrev_b32 v3, 4, v0
    v_lshlrev_b32 v3, 6, v3
    s_lshl_b32 s48, s46, 8
    v_add_u32 v3, s48, v3
    v_add_u32 v2, v2, v3
    v_pk_fma_f32 v[128:129], v[64:65], v[56:57], v[128:129] op_sel:[0,0,0] op_sel_hi:[0,1,1]
    v_pk_fma_f32 v[136:137], v[64:65], v[60:61], v[136:137] op_sel:[0,0,0] op_sel_hi:[0,1,1] neg_lo:[1,0,0] neg_hi:[1,0,0]
    v_pk_fma_f32 v[128:129], v[66:67], v[60:61], v[128:129] op_sel:[0,0,0] op_sel_hi:[0,1,1] neg_lo:[1,0,0] neg_hi:[1,0,0]
    v_pk_fma_f32 v[136:137], v[66:67], v[56:57], v[136:137] op_sel:[0,0,0] op_sel_hi:[0,1,1] neg_lo:[1,0,0] neg_hi:[1,0,0]
    v_pk_fma_f32 v[130:131], v[68:69], v[56:57], v[130:131] op_sel:[0,0,0] op_sel_hi:[0,1,1]
    v_pk_fma_f32 v[138:139], v[68:69], v[60:61], v[138:139] op_sel:[0,0,0] op_sel_hi:[0,1,1] neg_lo:[1,0,0] neg_hi:[1,0,0]
    v_pk_fma_f32 v[130:131], v[70:71], v[60:61], v[130:131] op_sel:[0,0,0] op_sel_hi:[0,1,1] neg_lo:[1,0,0] neg_hi:[1,0,0]
    v_pk_fma_f32 v[138:139], v[70:71], v[56:57], v[138:139] op_sel:[0,0,0] op_sel_hi:[0,1,1] neg_lo:[1,0,0] neg_hi:[1,0,0]
    v_pk_fma_f32 v[144:145], v[72:73], v[56:57], v[144:145] op_sel:[0,0,0] op_sel_hi:[0,1,1]
    v_pk_fma_f32 v[152:153], v[72:73], v[60:61], v[152:153] op_sel:[0,0,0] op_sel_hi:[0,1,1] neg_lo:[1,0,0] neg_hi:[1,0,0]
    v_pk_fma_f32 v[144:145], v[74:75], v[60:61], v[144:145] op_sel:[0,0,0] op_sel_hi:[0,1,1] neg_lo:[1,0,0] neg_hi:[1,0,0]
    v_pk_fma_f32 v[152:153], v[74:75], v[56:57], v[152:153] op_sel:[0,0,0] op_sel_hi:[0,1,1] neg_lo:[1,0,0] neg_hi:[1,0,0]
    v_pk_fma_f32 v[146:147], v[76:77], v[56:57], v[146:147] op_sel:[0,0,0] op_sel_hi:[0,1,1]
    v_pk_fma_f32 v[154:155], v[76:77], v[60:61], v[154:155] op_sel:[0,0,0] op_sel_hi:[0,1,1] neg_lo:[1,0,0] neg_hi:[1,0,0]
    v_pk_fma_f32 v[146:147], v[78:79], v[60:61], v[146:147] op_sel:[0,0,0] op_sel_hi:[0,1,1] neg_lo:[1,0,0] neg_hi:[1,0,0]
    v_pk_fma_f32 v[154:155], v[78:79], v[56:57], v[154:155] op_sel:[0,0,0] op_sel_hi:[0,1,1] neg_lo:[1,0,0] neg_hi:[1,0,0]
    v_pk_fma_f32 v[160:161], v[80:81], v[56:57], v[160:161] op_sel:[0,0,0] op_sel_hi:[0,1,1]
    v_pk_fma_f32 v[168:169], v[80:81], v[60:61], v[168:169] op_sel:[0,0,0] op_sel_hi:[0,1,1] neg_lo:[1,0,0] neg_hi:[1,0,0]
    v_pk_fma_f32 v[160:161], v[82:83], v[60:61], v[160:161] op_sel:[0,0,0] op_sel_hi:[0,1,1] neg_lo:[1,0,0] neg_hi:[1,0,0]
    v_pk_fma_f32 v[168:169], v[82:83], v[56:57], v[168:169] op_sel:[0,0,0] op_sel_hi:[0,1,1] neg_lo:[1,0,0] neg_hi:[1,0,0]
    v_pk_fma_f32 v[162:163], v[84:85], v[56:57], v[162:163] op_sel:[0,0,0] op_sel_hi:[0,1,1]
    v_pk_fma_f32 v[170:171], v[84:85], v[60:61], v[170:171] op_sel:[0,0,0] op_sel_hi:[0,1,1] neg_lo:[1,0,0] neg_hi:[1,0,0]
    v_pk_fma_f32 v[162:163], v[86:87], v[60:61], v[162:163] op_sel:[0,0,0] op_sel_hi:[0,1,1] neg_lo:[1,0,0] neg_hi:[1,0,0]
    v_pk_fma_f32 v[170:171], v[86:87], v[56:57], v[170:171] op_sel:[0,0,0] op_sel_hi:[0,1,1] neg_lo:[1,0,0] neg_hi:[1,0,0]
    v_pk_fma_f32 v[176:177], v[88:89], v[56:57], v[176:177] op_sel:[0,0,0] op_sel_hi:[0,1,1]
    v_pk_fma_f32 v[184:185], v[88:89], v[60:61], v[184:185] op_sel:[0,0,0] op_sel_hi:[0,1,1] neg_lo:[1,0,0] neg_hi:[1,0,0]
    v_pk_fma_f32 v[176:177], v[90:91], v[60:61], v[176:177] op_sel:[0,0,0] op_sel_hi:[0,1,1] neg_lo:[1,0,0] neg_hi:[1,0,0]
    v_pk_fma_f32 v[184:185], v[90:91], v[56:57], v[184:185] op_sel:[0,0,0] op_sel_hi:[0,1,1] neg_lo:[1,0,0] neg_hi:[1,0,0]
    v_pk_fma_f32 v[178:179], v[92:93], v[56:57], v[178:179] op_sel:[0,0,0] op_sel_hi:[0,1,1]
    v_pk_fma_f32 v[186:187], v[92:93], v[60:61], v[186:187] op_sel:[0,0,0] op_sel_hi:[0,1,1] neg_lo:[1,0,0] neg_hi:[1,0,0]
    v_pk_fma_f32 v[178:179], v[94:95], v[60:61], v[178:179] op_sel:[0,0,0] op_sel_hi:[0,1,1] neg_lo:[1,0,0] neg_hi:[1,0,0]
    v_pk_fma_f32 v[186:187], v[94:95], v[56:57], v[186:187] op_sel:[0,0,0] op_sel_hi:[0,1,1] neg_lo:[1,0,0] neg_hi:[1,0,0]
    v_pk_fma_f32 v[192:193], v[96:97], v[56:57], v[192:193] op_sel:[0,0,0] op_sel_hi:[0,1,1]
    v_pk_fma_f32 v[200:201], v[96:97], v[60:61], v[200:201] op_sel:[0,0,0] op_sel_hi:[0,1,1] neg_lo:[1,0,0] neg_hi:[1,0,0]
    v_pk_fma_f32 v[192:193], v[98:99], v[60:61], v[192:193] op_sel:[0,0,0] op_sel_hi:[0,1,1] neg_lo:[1,0,0] neg_hi:[1,0,0]
    v_pk_fma_f32 v[200:201], v[98:99], v[56:57], v[200:201] op_sel:[0,0,0] op_sel_hi:[0,1,1] neg_lo:[1,0,0] neg_hi:[1,0,0]
    v_pk_fma_f32 v[194:195], v[100:101], v[56:57], v[194:195] op_sel:[0,0,0] op_sel_hi:[0,1,1]
    v_pk_fma_f32 v[202:203], v[100:101], v[60:61], v[202:203] op_sel:[0,0,0] op_sel_hi:[0,1,1] neg_lo:[1,0,0] neg_hi:[1,0,0]
    v_pk_fma_f32 v[194:195], v[102:103], v[60:61], v[194:195] op_sel:[0,0,0] op_sel_hi:[0,1,1] neg_lo:[1,0,0] neg_hi:[1,0,0]
    v_pk_fma_f32 v[202:203], v[102:103], v[56:57], v[202:203] op_sel:[0,0,0] op_sel_hi:[0,1,1] neg_lo:[1,0,0] neg_hi:[1,0,0]
    v_pk_fma_f32 v[208:209], v[104:105], v[56:57], v[208:209] op_sel:[0,0,0] op_sel_hi:[0,1,1]
    v_pk_fma_f32 v[216:217], v[104:105], v[60:61], v[216:217] op_sel:[0,0,0] op_sel_hi:[0,1,1] neg_lo:[1,0,0] neg_hi:[1,0,0]
    v_pk_fma_f32 v[208:209], v[106:107], v[60:61], v[208:209] op_sel:[0,0,0] op_sel_hi:[0,1,1] neg_lo:[1,0,0] neg_hi:[1,0,0]
    v_pk_fma_f32 v[216:217], v[106:107], v[56:57], v[216:217] op_sel:[0,0,0] op_sel_hi:[0,1,1] neg_lo:[1,0,0] neg_hi:[1,0,0]
    v_pk_fma_f32 v[210:211], v[108:109], v[56:57], v[210:211] op_sel:[0,0,0] op_sel_hi:[0,1,1]
    v_pk_fma_f32 v[218:219], v[108:109], v[60:61], v[218:219] op_sel:[0,0,0] op_sel_hi:[0,1,1] neg_lo:[1,0,0] neg_hi:[1,0,0]
    v_pk_fma_f32 v[210:211], v[110:111], v[60:61], v[210:211] op_sel:[0,0,0] op_sel_hi:[0,1,1] neg_lo:[1,0,0] neg_hi:[1,0,0]
    v_pk_fma_f32 v[218:219], v[110:111], v[56:57], v[218:219] op_sel:[0,0,0] op_sel_hi:[0,1,1] neg_lo:[1,0,0] neg_hi:[1,0,0]
    v_pk_fma_f32 v[224:225], v[112:113], v[56:57], v[224:225] op_sel:[0,0,0] op_sel_hi:[0,1,1]
    v_pk_fma_f32 v[232:233], v[112:113], v[60:61], v[232:233] op_sel:[0,0,0] op_sel_hi:[0,1,1] neg_lo:[1,0,0] neg_hi:[1,0,0]
    v_pk_fma_f32 v[224:225], v[114:115], v[60:61], v[224:225] op_sel:[0,0,0] op_sel_hi:[0,1,1] neg_lo:[1,0,0] neg_hi:[1,0,0]
    v_pk_fma_f32 v[232:233], v[114:115], v[56:57], v[232:233] op_sel:[0,0,0] op_sel_hi:[0,1,1] neg_lo:[1,0,0] neg_hi:[1,0,0]
    v_pk_fma_f32 v[226:227], v[116:117], v[56:57], v[226:227] op_sel:[0,0,0] op_sel_hi:[0,1,1]
    v_pk_fma_f32 v[234:235], v[116:117], v[60:61], v[234:235] op_sel:[0,0,0] op_sel_hi:[0,1,1] neg_lo:[1,0,0] neg_hi:[1,0,0]
    v_pk_fma_f32 v[226:227], v[118:119], v[60:61], v[226:227] op_sel:[0,0,0] op_sel_hi:[0,1,1] neg_lo:[1,0,0] neg_hi:[1,0,0]
    v_pk_fma_f32 v[234:235], v[118:119], v[56:57], v[234:235] op_sel:[0,0,0] op_sel_hi:[0,1,1] neg_lo:[1,0,0] neg_hi:[1,0,0]
    v_pk_fma_f32 v[240:241], v[120:121], v[56:57], v[240:241] op_sel:[0,0,0] op_sel_hi:[0,1,1]
    v_pk_fma_f32 v[248:249], v[120:121], v[60:61], v[248:249] op_sel:[0,0,0] op_sel_hi:[0,1,1] neg_lo:[1,0,0] neg_hi:[1,0,0]
    v_pk_fma_f32 v[240:241], v[122:123], v[60:61], v[240:241] op_sel:[0,0,0] op_sel_hi:[0,1,1] neg_lo:[1,0,0] neg_hi:[1,0,0]
    v_pk_fma_f32 v[248:249], v[122:123], v[56:57], v[248:249] op_sel:[0,0,0] op_sel_hi:[0,1,1] neg_lo:[1,0,0] neg_hi:[1,0,0]
    v_pk_fma_f32 v[242:243], v[124:125], v[56:57], v[242:243] op_sel:[0,0,0] op_sel_hi:[0,1,1]
    v_pk_fma_f32 v[250:251], v[124:125], v[60:61], v[250:251] op_sel:[0,0,0] op_sel_hi:[0,1,1] neg_lo:[1,0,0] neg_hi:[1,0,0]
    v_pk_fma_f32 v[242:243], v[126:127], v[60:61], v[242:243] op_sel:[0,0,0] op_sel_hi:[0,1,1] neg_lo:[1,0,0] neg_hi:[1,0,0]
    v_pk_fma_f32 v[250:251], v[126:127], v[56:57], v[250:251] op_sel:[0,0,0] op_sel_hi:[0,1,1] neg_lo:[1,0,0] neg_hi:[1,0,0]
    v_cvt_pk_bf16_f32 v4, v128, v130
    v_cvt_pk_bf16_f32 v5, v144, v146
    v_cvt_pk_bf16_f32 v6, v160, v162
    v_cvt_pk_bf16_f32 v7, v176, v178
    v_cvt_pk_bf16_f32 v8, v192, v194
    v_cvt_pk_bf16_f32 v9, v208, v210
    v_cvt_pk_bf16_f32 v10, v224, v226
    v_cvt_pk_bf16_f32 v11, v240, v242
    v_cvt_pk_bf16_f32 v12, v129, v131
    v_cvt_pk_bf16_f32 v13, v145, v147
    v_cvt_pk_bf16_f32 v14, v161, v163
    v_cvt_pk_bf16_f32 v15, v177, v179
    v_cvt_pk_bf16_f32 v16, v193, v195
    v_cvt_pk_bf16_f32 v17, v209, v211
    v_cvt_pk_bf16_f32 v18, v225, v227
    v_cvt_pk_bf16_f32 v19, v241, v243
    ds_write_b128 v2, v[4:7] offset:0
    ds_write_b128 v2, v[8:11] offset:16
    ds_write_b128 v2, v[12:15] offset:32
    ds_write_b128 v2, v[16:19] offset:48
    v_cvt_pk_bf16_f32 v36, v136, v138
    v_cvt_pk_bf16_f32 v37, v152, v154
    v_cvt_pk_bf16_f32 v38, v168, v170
    v_cvt_pk_bf16_f32 v39, v184, v186
    v_cvt_pk_bf16_f32 v40, v200, v202
    v_cvt_pk_bf16_f32 v41, v216, v218
    v_cvt_pk_bf16_f32 v42, v232, v234
    v_cvt_pk_bf16_f32 v43, v248, v250
    v_cvt_pk_bf16_f32 v44, v137, v139
    v_cvt_pk_bf16_f32 v45, v153, v155
    v_cvt_pk_bf16_f32 v46, v169, v171
    v_cvt_pk_bf16_f32 v47, v185, v187
    v_cvt_pk_bf16_f32 v48, v201, v203
    v_cvt_pk_bf16_f32 v49, v217, v219
    v_cvt_pk_bf16_f32 v50, v233, v235
    v_cvt_pk_bf16_f32 v51, v249, v251
    ds_write_b128 v2, v[36:39] offset:33792
    ds_write_b128 v2, v[40:43] offset:33808
    ds_write_b128 v2, v[44:47] offset:33824
    ds_write_b128 v2, v[48:51] offset:33840
    s_waitcnt lgkmcnt(0)
    s_barrier
    v_pk_fma_f32 v[132:133], v[64:65], v[58:59], v[132:133] op_sel:[1,0,0] op_sel_hi:[1,1,1]
    v_pk_fma_f32 v[140:141], v[64:65], v[62:63], v[140:141] op_sel:[1,0,0] op_sel_hi:[1,1,1] neg_lo:[1,0,0] neg_hi:[1,0,0]
    v_pk_fma_f32 v[132:133], v[66:67], v[62:63], v[132:133] op_sel:[1,0,0] op_sel_hi:[1,1,1] neg_lo:[1,0,0] neg_hi:[1,0,0]
    v_pk_fma_f32 v[140:141], v[66:67], v[58:59], v[140:141] op_sel:[1,0,0] op_sel_hi:[1,1,1] neg_lo:[1,0,0] neg_hi:[1,0,0]
    v_pk_fma_f32 v[134:135], v[68:69], v[58:59], v[134:135] op_sel:[1,0,0] op_sel_hi:[1,1,1]
    v_pk_fma_f32 v[142:143], v[68:69], v[62:63], v[142:143] op_sel:[1,0,0] op_sel_hi:[1,1,1] neg_lo:[1,0,0] neg_hi:[1,0,0]
    v_pk_fma_f32 v[134:135], v[70:71], v[62:63], v[134:135] op_sel:[1,0,0] op_sel_hi:[1,1,1] neg_lo:[1,0,0] neg_hi:[1,0,0]
    v_pk_fma_f32 v[142:143], v[70:71], v[58:59], v[142:143] op_sel:[1,0,0] op_sel_hi:[1,1,1] neg_lo:[1,0,0] neg_hi:[1,0,0]
    v_pk_fma_f32 v[148:149], v[72:73], v[58:59], v[148:149] op_sel:[1,0,0] op_sel_hi:[1,1,1]
    v_pk_fma_f32 v[156:157], v[72:73], v[62:63], v[156:157] op_sel:[1,0,0] op_sel_hi:[1,1,1] neg_lo:[1,0,0] neg_hi:[1,0,0]
    v_pk_fma_f32 v[148:149], v[74:75], v[62:63], v[148:149] op_sel:[1,0,0] op_sel_hi:[1,1,1] neg_lo:[1,0,0] neg_hi:[1,0,0]
    v_pk_fma_f32 v[156:157], v[74:75], v[58:59], v[156:157] op_sel:[1,0,0] op_sel_hi:[1,1,1] neg_lo:[1,0,0] neg_hi:[1,0,0]
    v_pk_fma_f32 v[150:151], v[76:77], v[58:59], v[150:151] op_sel:[1,0,0] op_sel_hi:[1,1,1]
    v_pk_fma_f32 v[158:159], v[76:77], v[62:63], v[158:159] op_sel:[1,0,0] op_sel_hi:[1,1,1] neg_lo:[1,0,0] neg_hi:[1,0,0]
    v_pk_fma_f32 v[150:151], v[78:79], v[62:63], v[150:151] op_sel:[1,0,0] op_sel_hi:[1,1,1] neg_lo:[1,0,0] neg_hi:[1,0,0]
    v_pk_fma_f32 v[158:159], v[78:79], v[58:59], v[158:159] op_sel:[1,0,0] op_sel_hi:[1,1,1] neg_lo:[1,0,0] neg_hi:[1,0,0]
    v_pk_fma_f32 v[164:165], v[80:81], v[58:59], v[164:165] op_sel:[1,0,0] op_sel_hi:[1,1,1]
    v_pk_fma_f32 v[172:173], v[80:81], v[62:63], v[172:173] op_sel:[1,0,0] op_sel_hi:[1,1,1] neg_lo:[1,0,0] neg_hi:[1,0,0]
    v_pk_fma_f32 v[164:165], v[82:83], v[62:63], v[164:165] op_sel:[1,0,0] op_sel_hi:[1,1,1] neg_lo:[1,0,0] neg_hi:[1,0,0]
    v_pk_fma_f32 v[172:173], v[82:83], v[58:59], v[172:173] op_sel:[1,0,0] op_sel_hi:[1,1,1] neg_lo:[1,0,0] neg_hi:[1,0,0]
    v_pk_fma_f32 v[166:167], v[84:85], v[58:59], v[166:167] op_sel:[1,0,0] op_sel_hi:[1,1,1]
    v_pk_fma_f32 v[174:175], v[84:85], v[62:63], v[174:175] op_sel:[1,0,0] op_sel_hi:[1,1,1] neg_lo:[1,0,0] neg_hi:[1,0,0]
    v_pk_fma_f32 v[166:167], v[86:87], v[62:63], v[166:167] op_sel:[1,0,0] op_sel_hi:[1,1,1] neg_lo:[1,0,0] neg_hi:[1,0,0]
    v_pk_fma_f32 v[174:175], v[86:87], v[58:59], v[174:175] op_sel:[1,0,0] op_sel_hi:[1,1,1] neg_lo:[1,0,0] neg_hi:[1,0,0]
    v_pk_fma_f32 v[180:181], v[88:89], v[58:59], v[180:181] op_sel:[1,0,0] op_sel_hi:[1,1,1]
    v_pk_fma_f32 v[188:189], v[88:89], v[62:63], v[188:189] op_sel:[1,0,0] op_sel_hi:[1,1,1] neg_lo:[1,0,0] neg_hi:[1,0,0]
    v_pk_fma_f32 v[180:181], v[90:91], v[62:63], v[180:181] op_sel:[1,0,0] op_sel_hi:[1,1,1] neg_lo:[1,0,0] neg_hi:[1,0,0]
    v_pk_fma_f32 v[188:189], v[90:91], v[58:59], v[188:189] op_sel:[1,0,0] op_sel_hi:[1,1,1] neg_lo:[1,0,0] neg_hi:[1,0,0]
    v_pk_fma_f32 v[182:183], v[92:93], v[58:59], v[182:183] op_sel:[1,0,0] op_sel_hi:[1,1,1]
    v_pk_fma_f32 v[190:191], v[92:93], v[62:63], v[190:191] op_sel:[1,0,0] op_sel_hi:[1,1,1] neg_lo:[1,0,0] neg_hi:[1,0,0]
    v_pk_fma_f32 v[182:183], v[94:95], v[62:63], v[182:183] op_sel:[1,0,0] op_sel_hi:[1,1,1] neg_lo:[1,0,0] neg_hi:[1,0,0]
    v_pk_fma_f32 v[190:191], v[94:95], v[58:59], v[190:191] op_sel:[1,0,0] op_sel_hi:[1,1,1] neg_lo:[1,0,0] neg_hi:[1,0,0]
    v_pk_fma_f32 v[196:197], v[96:97], v[58:59], v[196:197] op_sel:[1,0,0] op_sel_hi:[1,1,1]
    v_pk_fma_f32 v[204:205], v[96:97], v[62:63], v[204:205] op_sel:[1,0,0] op_sel_hi:[1,1,1] neg_lo:[1,0,0] neg_hi:[1,0,0]
    v_pk_fma_f32 v[196:197], v[98:99], v[62:63], v[196:197] op_sel:[1,0,0] op_sel_hi:[1,1,1] neg_lo:[1,0,0] neg_hi:[1,0,0]
    v_pk_fma_f32 v[204:205], v[98:99], v[58:59], v[204:205] op_sel:[1,0,0] op_sel_hi:[1,1,1] neg_lo:[1,0,0] neg_hi:[1,0,0]
    v_pk_fma_f32 v[198:199], v[100:101], v[58:59], v[198:199] op_sel:[1,0,0] op_sel_hi:[1,1,1]
    v_pk_fma_f32 v[206:207], v[100:101], v[62:63], v[206:207] op_sel:[1,0,0] op_sel_hi:[1,1,1] neg_lo:[1,0,0] neg_hi:[1,0,0]
    v_pk_fma_f32 v[198:199], v[102:103], v[62:63], v[198:199] op_sel:[1,0,0] op_sel_hi:[1,1,1] neg_lo:[1,0,0] neg_hi:[1,0,0]
    v_pk_fma_f32 v[206:207], v[102:103], v[58:59], v[206:207] op_sel:[1,0,0] op_sel_hi:[1,1,1] neg_lo:[1,0,0] neg_hi:[1,0,0]
    v_pk_fma_f32 v[212:213], v[104:105], v[58:59], v[212:213] op_sel:[1,0,0] op_sel_hi:[1,1,1]
    v_pk_fma_f32 v[220:221], v[104:105], v[62:63], v[220:221] op_sel:[1,0,0] op_sel_hi:[1,1,1] neg_lo:[1,0,0] neg_hi:[1,0,0]
    v_pk_fma_f32 v[212:213], v[106:107], v[62:63], v[212:213] op_sel:[1,0,0] op_sel_hi:[1,1,1] neg_lo:[1,0,0] neg_hi:[1,0,0]
    v_pk_fma_f32 v[220:221], v[106:107], v[58:59], v[220:221] op_sel:[1,0,0] op_sel_hi:[1,1,1] neg_lo:[1,0,0] neg_hi:[1,0,0]
    v_pk_fma_f32 v[214:215], v[108:109], v[58:59], v[214:215] op_sel:[1,0,0] op_sel_hi:[1,1,1]
    v_pk_fma_f32 v[222:223], v[108:109], v[62:63], v[222:223] op_sel:[1,0,0] op_sel_hi:[1,1,1] neg_lo:[1,0,0] neg_hi:[1,0,0]
    v_pk_fma_f32 v[214:215], v[110:111], v[62:63], v[214:215] op_sel:[1,0,0] op_sel_hi:[1,1,1] neg_lo:[1,0,0] neg_hi:[1,0,0]
    v_pk_fma_f32 v[222:223], v[110:111], v[58:59], v[222:223] op_sel:[1,0,0] op_sel_hi:[1,1,1] neg_lo:[1,0,0] neg_hi:[1,0,0]
    v_pk_fma_f32 v[228:229], v[112:113], v[58:59], v[228:229] op_sel:[1,0,0] op_sel_hi:[1,1,1]
    v_pk_fma_f32 v[236:237], v[112:113], v[62:63], v[236:237] op_sel:[1,0,0] op_sel_hi:[1,1,1] neg_lo:[1,0,0] neg_hi:[1,0,0]
    v_pk_fma_f32 v[228:229], v[114:115], v[62:63], v[228:229] op_sel:[1,0,0] op_sel_hi:[1,1,1] neg_lo:[1,0,0] neg_hi:[1,0,0]
    v_pk_fma_f32 v[236:237], v[114:115], v[58:59], v[236:237] op_sel:[1,0,0] op_sel_hi:[1,1,1] neg_lo:[1,0,0] neg_hi:[1,0,0]
    v_pk_fma_f32 v[230:231], v[116:117], v[58:59], v[230:231] op_sel:[1,0,0] op_sel_hi:[1,1,1]
    v_pk_fma_f32 v[238:239], v[116:117], v[62:63], v[238:239] op_sel:[1,0,0] op_sel_hi:[1,1,1] neg_lo:[1,0,0] neg_hi:[1,0,0]
    v_pk_fma_f32 v[230:231], v[118:119], v[62:63], v[230:231] op_sel:[1,0,0] op_sel_hi:[1,1,1] neg_lo:[1,0,0] neg_hi:[1,0,0]
    v_pk_fma_f32 v[238:239], v[118:119], v[58:59], v[238:239] op_sel:[1,0,0] op_sel_hi:[1,1,1] neg_lo:[1,0,0] neg_hi:[1,0,0]
    v_pk_fma_f32 v[244:245], v[120:121], v[58:59], v[244:245] op_sel:[1,0,0] op_sel_hi:[1,1,1]
    v_pk_fma_f32 v[252:253], v[120:121], v[62:63], v[252:253] op_sel:[1,0,0] op_sel_hi:[1,1,1] neg_lo:[1,0,0] neg_hi:[1,0,0]
    v_pk_fma_f32 v[244:245], v[122:123], v[62:63], v[244:245] op_sel:[1,0,0] op_sel_hi:[1,1,1] neg_lo:[1,0,0] neg_hi:[1,0,0]
    v_pk_fma_f32 v[252:253], v[122:123], v[58:59], v[252:253] op_sel:[1,0,0] op_sel_hi:[1,1,1] neg_lo:[1,0,0] neg_hi:[1,0,0]
    v_pk_fma_f32 v[246:247], v[124:125], v[58:59], v[246:247] op_sel:[1,0,0] op_sel_hi:[1,1,1]
    v_pk_fma_f32 v[254:255], v[124:125], v[62:63], v[254:255] op_sel:[1,0,0] op_sel_hi:[1,1,1] neg_lo:[1,0,0] neg_hi:[1,0,0]
    v_pk_fma_f32 v[246:247], v[126:127], v[62:63], v[246:247] op_sel:[1,0,0] op_sel_hi:[1,1,1] neg_lo:[1,0,0] neg_hi:[1,0,0]
    v_pk_fma_f32 v[254:255], v[126:127], v[58:59], v[254:255] op_sel:[1,0,0] op_sel_hi:[1,1,1] neg_lo:[1,0,0] neg_hi:[1,0,0]
    v_cvt_pk_bf16_f32 v4, v132, v134
    v_cvt_pk_bf16_f32 v5, v148, v150
    v_cvt_pk_bf16_f32 v6, v164, v166
    v_cvt_pk_bf16_f32 v7, v180, v182
    v_cvt_pk_bf16_f32 v8, v196, v198
    v_cvt_pk_bf16_f32 v9, v212, v214
    v_cvt_pk_bf16_f32 v10, v228, v230
    v_cvt_pk_bf16_f32 v11, v244, v246
    v_cvt_pk_bf16_f32 v12, v133, v135
    v_cvt_pk_bf16_f32 v13, v149, v151
    v_cvt_pk_bf16_f32 v14, v165, v167
    v_cvt_pk_bf16_f32 v15, v181, v183
    v_cvt_pk_bf16_f32 v16, v197, v199
    v_cvt_pk_bf16_f32 v17, v213, v215
    v_cvt_pk_bf16_f32 v18, v229, v231
    v_cvt_pk_bf16_f32 v19, v245, v247
    ds_write_b128 v2, v[4:7] offset:8448
    ds_write_b128 v2, v[8:11] offset:8464
    ds_write_b128 v2, v[12:15] offset:8480
    ds_write_b128 v2, v[16:19] offset:8496
    v_cvt_pk_bf16_f32 v36, v140, v142
    v_cvt_pk_bf16_f32 v37, v156, v158
    v_cvt_pk_bf16_f32 v38, v172, v174
    v_cvt_pk_bf16_f32 v39, v188, v190
    v_cvt_pk_bf16_f32 v40, v204, v206
    v_cvt_pk_bf16_f32 v41, v220, v222
    v_cvt_pk_bf16_f32 v42, v236, v238
    v_cvt_pk_bf16_f32 v43, v252, v254
    v_cvt_pk_bf16_f32 v44, v141, v143
    v_cvt_pk_bf16_f32 v45, v157, v159
    v_cvt_pk_bf16_f32 v46, v173, v175
    v_cvt_pk_bf16_f32 v47, v189, v191
    v_cvt_pk_bf16_f32 v48, v205, v207
    v_cvt_pk_bf16_f32 v49, v221, v223
    v_cvt_pk_bf16_f32 v50, v237, v239
    v_cvt_pk_bf16_f32 v51, v253, v255
    ds_write_b128 v2, v[36:39] offset:42240
    ds_write_b128 v2, v[40:43] offset:42256
    ds_write_b128 v2, v[44:47] offset:42272
    ds_write_b128 v2, v[48:51] offset:42288
    s_waitcnt lgkmcnt(0)
    s_barrier
L_final:
    s_lshr_b32 s55, s45, 1
    s_lshl_b32 s55, s55, 2
    s_and_b32 s54, s45, 1
    s_add_u32 s55, s55, s54
    s_add_u32 s55, s55, 2
    v_bfe_u32 v1, v0, 2, 2
    s_mov_b32 s49, 528
    v_mul_lo_u32 v1, v1, s49
    v_lshrrev_b32 v2, 4, v0
    v_lshlrev_b32 v2, 5, v2
    v_add_u32 v1, v1, v2
    v_and_b32 v2, 3, v0
    v_lshlrev_b32 v2, 3, v2
    v_add_u32 v1, v1, v2
    s_mul_i32 s48, s55, 4224
    v_add_u32 v1, s48, v1
    s_lshl_b32 s48, s42, 8
    s_lshr_b32 s49, s55, 3
    s_lshl_b32 s49, s49, 7
    s_add_u32 s48, s48, s49
    s_lshr_b32 s49, s43, 3
    s_add_u32 s48, s48, s49
    s_and_b32 s49, s55, 7
    s_add_u32 s48, s48, s49
    s_lshl_b32 s48, s48, 11
    s_lshl_b32 s49, s40, 21
    s_add_u32 s48, s48, s49
    v_lshlrev_b32 v2, 4, v0
    s_mov_b32 s98, s55
    s_lshl_b32 s63, s41, 3
    s_add_u32 s63, s63, s40
    s_lshl_b32 s63, s63, 10
    s_add_u32 s63, s63, 16777728
    s_mov_b32 s58, s63
    ds_read_b64_tr_b16 v[64:65], v1 offset:0
    ds_read_b64_tr_b16 v[66:67], v1 offset:2112
    ds_read_b64_tr_b16 v[68:69], v1 offset:128
    ds_read_b64_tr_b16 v[70:71], v1 offset:2240
    ds_read_b64_tr_b16 v[72:73], v1 offset:256
    ds_read_b64_tr_b16 v[74:75], v1 offset:2368
    ds_read_b64_tr_b16 v[76:77], v1 offset:384
    ds_read_b64_tr_b16 v[78:79], v1 offset:2496
    s_add_u32 s54, s98, 0
    s_and_b32 s54, s54, 3
    s_lshl_b32 s99, s42, 1
    s_and_b32 s54, s99, 3
    s_lshl_b32 s54, s54, 8
    v_xor_b32 v5, s54, v2
    s_lshr_b32 s99, s99, 2
    s_lshl_b32 s99, s99, 10
    s_xor_b32 s49, s99, 0
    s_add_u32 s49, s49, s48
    s_add_u32 s49, s49, 0
    s_waitcnt lgkmcnt(6)
    buffer_store_dwordx4 v[64:67], v5, s[20:23], s49 offen sc1
    s_xor_b32 s49, s99, 1024
    s_add_u32 s49, s49, s48
    s_add_u32 s49, s49, 0
    s_waitcnt lgkmcnt(4)
    buffer_store_dwordx4 v[68:71], v5, s[20:23], s49 offen sc1
    s_xor_b32 s49, s99, 0
    s_add_u32 s49, s49, s48
    s_add_u32 s49, s49, 1048576
    s_waitcnt lgkmcnt(2)
    buffer_store_dwordx4 v[72:75], v5, s[20:23], s49 offen sc1
    s_xor_b32 s49, s99, 1024
    s_add_u32 s49, s49, s48
    s_add_u32 s49, s49, 1048576
    s_waitcnt lgkmcnt(0)
    buffer_store_dwordx4 v[76:79], v5, s[20:23], s49 offen sc1
    s_cmp_eq_u32 s3, 1
    s_cbranch_scc1 L_fin_ld
    s_mov_b32 s94, s40
    s_mov_b32 s95, s41
    s_bfe_u32 s60, s2, 0x20001
    s_lshl_b32 s60, s60, 2
    s_bfe_u32 s62, s2, 0x20003
    s_add_u32 s60, s60, s62
    s_lshl_b32 s60, s60, 7
    s_and_b32 s62, s2, 1
    s_lshl_b32 s62, s62, 3
    s_lshr_b32 s63, s2, 5
    s_add_u32 s62, s62, s63
    s_lshl_b32 s62, s62, 6
    s_mov_b32 s40, s60
    s_mov_b32 s41, s62
    s_lshr_b32 s46, s45, 1
    s_and_b32 s47, s45, 1
    s_mov_b32 s24, s88
    s_mov_b32 s25, s89
    s_mov_b32 s26, 0x800000
    s_mov_b32 s27, 0x00020000
    s_cmp_eq_u32 s46, 0
    s_cselect_b32 s68, s90, s92
    s_cselect_b32 s69, s91, s93
    s_mov_b32 s70, 2048
    s_mov_b32 s71, 0x00020000
    s_cselect_b32 s72, s92, s90
    s_cselect_b32 s73, s93, s91
    s_mov_b32 s74, 2048
    s_mov_b32 s75, 0x00020000
    v_and_b32 v1, 15, v0
    v_lshrrev_b32 v2, 4, v0
    v_lshlrev_b32 v3, 11, v2
    v_lshlrev_b32 v4, 4, v1
    v_add_u32 v3, v3, v4
    s_lshl_b32 s48, s40, 13
    s_lshl_b32 s49, s46, 19
    s_add_u32 s48, s48, s49
    v_add_u32 v3, s48, v3
    s_lshl_b32 s49, s46, 1
    v_mov_b32 v4, s49
    s_lshl_b32 s49, s47, 2
    v_xor_b32 v4, s49, v4
    v_xor_b32 v5, 0, v4
    v_lshlrev_b32 v5, 8, v5
    v_add_u32 v20, v3, v5
    v_xor_b32 v5, 1, v4
    v_lshlrev_b32 v5, 8, v5
    v_add_u32 v21, v3, v5
    v_xor_b32 v5, 2, v4
    v_lshlrev_b32 v5, 8, v5
    v_add_u32 v8, v3, v5
    v_xor_b32 v5, 3, v4
    v_lshlrev_b32 v5, 8, v5
    v_add_u32 v9, v3, v5
    v_lshrrev_b32 v3, 1, v1
    v_lshlrev_b32 v5, 7, v1
    s_lshl_b32 s48, s46, 13
    s_add_u32 s48, s48, 81920
    v_add_u32 v4, 0, v2
    v_xor_b32 v4, v4, v3
    v_lshlrev_b32 v4, 4, v4
    v_add_u32 v4, v4, v5
    v_add_u32 v22, s48, v4
    v_add_u32 v4, 4, v2
    v_xor_b32 v4, v4, v3
    v_lshlrev_b32 v4, 4, v4
    v_add_u32 v4, v4, v5
    v_add_u32 v23, s48, v4
    s_lshl_b32 s48, s47, 6
    s_add_u32 s48, s48, s40
    v_add_u32 v6, s48, v1
    v_lshlrev_b32 v7, 3, v6
    s_lshl_b32 s49, s46, 2
    v_add_u32 v7, s49, v7
    s_mul_i32 s48, s46, 34816
    s_mul_i32 s49, s47, 17408
    s_add_u32 s48, s48, s49
    v_mul_u32_u24 v11, 272, v1
    v_lshlrev_b32 v12, 4, v2
    v_add_u32 v11, v11, v12
    v_add_u32 v11, s48, v11
    s_mov_b32 s48, 67584
    s_cmp_eq_u32 s47, 0
    s_cselect_b32 s48, 155648, s48
    v_lshlrev_b32 v12, 7, v1
    v_lshrrev_b32 v13, 4, v0
    v_lshlrev_b32 v13, 3, v13
    v_add_u32 v12, v12, v13
    v_add_u32 v12, s48, v12
    ds_read_b64 v[160:161], v12 offset:0
    ds_read_b64 v[162:163], v12 offset:32
    ds_read_b64 v[164:165], v12 offset:64
    ds_read_b64 v[166:167], v12 offset:96
    ds_read_b64 v[168:169], v12 offset:2048
    ds_read_b64 v[170:171], v12 offset:2080
    ds_read_b64 v[172:173], v12 offset:2112
    ds_read_b64 v[174:175], v12 offset:2144
    ds_read_b64 v[176:177], v12 offset:4096
    ds_read_b64 v[178:179], v12 offset:4128
    ds_read_b64 v[180:181], v12 offset:4160
    ds_read_b64 v[182:183], v12 offset:4192
    ds_read_b64 v[184:185], v12 offset:6144
    ds_read_b64 v[186:187], v12 offset:6176
    ds_read_b64 v[188:189], v12 offset:6208
    ds_read_b64 v[190:191], v12 offset:6240
    s_lshl_b32 s48, s46, 7
    s_add_u32 s49, s48, 75776
    v_add_u32 v14, s49, v13
    ds_read_b64 v[144:145], v14 offset:0
    ds_read_b64 v[146:147], v14 offset:32
    ds_read_b64 v[148:149], v14 offset:64
    ds_read_b64 v[150:151], v14 offset:96
    s_waitcnt lgkmcnt(0)
    v_lshlrev_b32 v128, 16, v144
    v_and_b32 v129, 0xffff0000, v144
    v_lshlrev_b32 v130, 16, v145
    v_and_b32 v131, 0xffff0000, v145
    v_lshlrev_b32 v132, 16, v146
    v_and_b32 v133, 0xffff0000, v146
    v_lshlrev_b32 v134, 16, v147
    v_and_b32 v135, 0xffff0000, v147
    v_lshlrev_b32 v136, 16, v148
    v_and_b32 v137, 0xffff0000, v148
    v_lshlrev_b32 v138, 16, v149
    v_and_b32 v139, 0xffff0000, v149
    v_lshlrev_b32 v140, 16, v150
    v_and_b32 v141, 0xffff0000, v150
    v_lshlrev_b32 v142, 16, v151
    v_and_b32 v143, 0xffff0000, v151
    v_lshlrev_b32 v12, 16, v160
    v_and_b32 v13, 0xffff0000, v160
    v_pk_mul_f32 v[12:13], v[12:13], v[128:129] op_sel:[0,0] op_sel_hi:[1,1]
    v_cvt_pk_bf16_f32 v160, v12, v13
    v_lshlrev_b32 v14, 16, v161
    v_and_b32 v15, 0xffff0000, v161
    v_pk_mul_f32 v[14:15], v[14:15], v[130:131] op_sel:[0,0] op_sel_hi:[1,1]
    v_cvt_pk_bf16_f32 v161, v14, v15
    v_lshlrev_b32 v16, 16, v162
    v_and_b32 v17, 0xffff0000, v162
    v_pk_mul_f32 v[16:17], v[16:17], v[132:133] op_sel:[0,0] op_sel_hi:[1,1]
    v_cvt_pk_bf16_f32 v162, v16, v17
    v_lshlrev_b32 v18, 16, v163
    v_and_b32 v19, 0xffff0000, v163
    v_pk_mul_f32 v[18:19], v[18:19], v[134:135] op_sel:[0,0] op_sel_hi:[1,1]
    v_cvt_pk_bf16_f32 v163, v18, v19
    v_lshlrev_b32 v12, 16, v164
    v_and_b32 v13, 0xffff0000, v164
    v_pk_mul_f32 v[12:13], v[12:13], v[136:137] op_sel:[0,0] op_sel_hi:[1,1]
    v_cvt_pk_bf16_f32 v164, v12, v13
    v_lshlrev_b32 v14, 16, v165
    v_and_b32 v15, 0xffff0000, v165
    v_pk_mul_f32 v[14:15], v[14:15], v[138:139] op_sel:[0,0] op_sel_hi:[1,1]
    v_cvt_pk_bf16_f32 v165, v14, v15
    v_lshlrev_b32 v16, 16, v166
    v_and_b32 v17, 0xffff0000, v166
    v_pk_mul_f32 v[16:17], v[16:17], v[140:141] op_sel:[0,0] op_sel_hi:[1,1]
    v_cvt_pk_bf16_f32 v166, v16, v17
    v_lshlrev_b32 v18, 16, v167
    v_and_b32 v19, 0xffff0000, v167
    v_pk_mul_f32 v[18:19], v[18:19], v[142:143] op_sel:[0,0] op_sel_hi:[1,1]
    v_cvt_pk_bf16_f32 v167, v18, v19
    v_lshlrev_b32 v12, 16, v168
    v_and_b32 v13, 0xffff0000, v168
    v_pk_mul_f32 v[12:13], v[12:13], v[128:129] op_sel:[0,0] op_sel_hi:[1,1]
    v_cvt_pk_bf16_f32 v168, v12, v13
    v_lshlrev_b32 v14, 16, v169
    v_and_b32 v15, 0xffff0000, v169
    v_pk_mul_f32 v[14:15], v[14:15], v[130:131] op_sel:[0,0] op_sel_hi:[1,1]
    v_cvt_pk_bf16_f32 v169, v14, v15
    v_lshlrev_b32 v16, 16, v170
    v_and_b32 v17, 0xffff0000, v170
    v_pk_mul_f32 v[16:17], v[16:17], v[132:133] op_sel:[0,0] op_sel_hi:[1,1]
    v_cvt_pk_bf16_f32 v170, v16, v17
    v_lshlrev_b32 v18, 16, v171
    v_and_b32 v19, 0xffff0000, v171
    v_pk_mul_f32 v[18:19], v[18:19], v[134:135] op_sel:[0,0] op_sel_hi:[1,1]
    v_cvt_pk_bf16_f32 v171, v18, v19
    v_lshlrev_b32 v12, 16, v172
    v_and_b32 v13, 0xffff0000, v172
    v_pk_mul_f32 v[12:13], v[12:13], v[136:137] op_sel:[0,0] op_sel_hi:[1,1]
    v_cvt_pk_bf16_f32 v172, v12, v13
    v_lshlrev_b32 v14, 16, v173
    v_and_b32 v15, 0xffff0000, v173
    v_pk_mul_f32 v[14:15], v[14:15], v[138:139] op_sel:[0,0] op_sel_hi:[1,1]
    v_cvt_pk_bf16_f32 v173, v14, v15
    v_lshlrev_b32 v16, 16, v174
    v_and_b32 v17, 0xffff0000, v174
    v_pk_mul_f32 v[16:17], v[16:17], v[140:141] op_sel:[0,0] op_sel_hi:[1,1]
    v_cvt_pk_bf16_f32 v174, v16, v17
    v_lshlrev_b32 v18, 16, v175
    v_and_b32 v19, 0xffff0000, v175
    v_pk_mul_f32 v[18:19], v[18:19], v[142:143] op_sel:[0,0] op_sel_hi:[1,1]
    v_cvt_pk_bf16_f32 v175, v18, v19
    v_lshlrev_b32 v12, 16, v176
    v_and_b32 v13, 0xffff0000, v176
    v_pk_mul_f32 v[12:13], v[12:13], v[128:129] op_sel:[0,0] op_sel_hi:[1,1]
    v_cvt_pk_bf16_f32 v176, v12, v13
    v_lshlrev_b32 v14, 16, v177
    v_and_b32 v15, 0xffff0000, v177
    v_pk_mul_f32 v[14:15], v[14:15], v[130:131] op_sel:[0,0] op_sel_hi:[1,1]
    v_cvt_pk_bf16_f32 v177, v14, v15
    v_lshlrev_b32 v16, 16, v178
    v_and_b32 v17, 0xffff0000, v178
    v_pk_mul_f32 v[16:17], v[16:17], v[132:133] op_sel:[0,0] op_sel_hi:[1,1]
    v_cvt_pk_bf16_f32 v178, v16, v17
    v_lshlrev_b32 v18, 16, v179
    v_and_b32 v19, 0xffff0000, v179
    v_pk_mul_f32 v[18:19], v[18:19], v[134:135] op_sel:[0,0] op_sel_hi:[1,1]
    v_cvt_pk_bf16_f32 v179, v18, v19
    v_lshlrev_b32 v12, 16, v180
    v_and_b32 v13, 0xffff0000, v180
    v_pk_mul_f32 v[12:13], v[12:13], v[136:137] op_sel:[0,0] op_sel_hi:[1,1]
    v_cvt_pk_bf16_f32 v180, v12, v13
    v_lshlrev_b32 v14, 16, v181
    v_and_b32 v15, 0xffff0000, v181
    v_pk_mul_f32 v[14:15], v[14:15], v[138:139] op_sel:[0,0] op_sel_hi:[1,1]
    v_cvt_pk_bf16_f32 v181, v14, v15
    v_lshlrev_b32 v16, 16, v182
    v_and_b32 v17, 0xffff0000, v182
    v_pk_mul_f32 v[16:17], v[16:17], v[140:141] op_sel:[0,0] op_sel_hi:[1,1]
    v_cvt_pk_bf16_f32 v182, v16, v17
    v_lshlrev_b32 v18, 16, v183
    v_and_b32 v19, 0xffff0000, v183
    v_pk_mul_f32 v[18:19], v[18:19], v[142:143] op_sel:[0,0] op_sel_hi:[1,1]
    v_cvt_pk_bf16_f32 v183, v18, v19
    v_lshlrev_b32 v12, 16, v184
    v_and_b32 v13, 0xffff0000, v184
    v_pk_mul_f32 v[12:13], v[12:13], v[128:129] op_sel:[0,0] op_sel_hi:[1,1]
    v_cvt_pk_bf16_f32 v184, v12, v13
    v_lshlrev_b32 v14, 16, v185
    v_and_b32 v15, 0xffff0000, v185
    v_pk_mul_f32 v[14:15], v[14:15], v[130:131] op_sel:[0,0] op_sel_hi:[1,1]
    v_cvt_pk_bf16_f32 v185, v14, v15
    v_lshlrev_b32 v16, 16, v186
    v_and_b32 v17, 0xffff0000, v186
    v_pk_mul_f32 v[16:17], v[16:17], v[132:133] op_sel:[0,0] op_sel_hi:[1,1]
    v_cvt_pk_bf16_f32 v186, v16, v17
    v_lshlrev_b32 v18, 16, v187
    v_and_b32 v19, 0xffff0000, v187
    v_pk_mul_f32 v[18:19], v[18:19], v[134:135] op_sel:[0,0] op_sel_hi:[1,1]
    v_cvt_pk_bf16_f32 v187, v18, v19
    v_lshlrev_b32 v12, 16, v188
    v_and_b32 v13, 0xffff0000, v188
    v_pk_mul_f32 v[12:13], v[12:13], v[136:137] op_sel:[0,0] op_sel_hi:[1,1]
    v_cvt_pk_bf16_f32 v188, v12, v13
    v_lshlrev_b32 v14, 16, v189
    v_and_b32 v15, 0xffff0000, v189
    v_pk_mul_f32 v[14:15], v[14:15], v[138:139] op_sel:[0,0] op_sel_hi:[1,1]
    v_cvt_pk_bf16_f32 v189, v14, v15
    v_lshlrev_b32 v16, 16, v190
    v_and_b32 v17, 0xffff0000, v190
    v_pk_mul_f32 v[16:17], v[16:17], v[140:141] op_sel:[0,0] op_sel_hi:[1,1]
    v_cvt_pk_bf16_f32 v190, v16, v17
    v_lshlrev_b32 v18, 16, v191
    v_and_b32 v19, 0xffff0000, v191
    v_pk_mul_f32 v[18:19], v[18:19], v[142:143] op_sel:[0,0] op_sel_hi:[1,1]
    v_cvt_pk_bf16_f32 v191, v18, v19
    v_mov_b32 v192, 0
    v_mov_b32 v193, 0
    v_mov_b32 v194, 0
    v_mov_b32 v195, 0
    v_mov_b32 v196, 0
    v_mov_b32 v197, 0
    v_mov_b32 v198, 0
    v_mov_b32 v199, 0
    v_mov_b32 v200, 0
    v_mov_b32 v201, 0
    v_mov_b32 v202, 0
    v_mov_b32 v203, 0
    v_mov_b32 v204, 0
    v_mov_b32 v205, 0
    v_mov_b32 v206, 0
    v_mov_b32 v207, 0
    v_mov_b32 v208, 0
    v_mov_b32 v209, 0
    v_mov_b32 v210, 0
    v_mov_b32 v211, 0
    v_mov_b32 v212, 0
    v_mov_b32 v213, 0
    v_mov_b32 v214, 0
    v_mov_b32 v215, 0
    v_mov_b32 v216, 0
    v_mov_b32 v217, 0
    v_mov_b32 v218, 0
    v_mov_b32 v219, 0
    v_mov_b32 v220, 0
    v_mov_b32 v221, 0
    v_mov_b32 v222, 0
    v_mov_b32 v223, 0
    v_mov_b32 v224, 0
    v_mov_b32 v225, 0
    v_mov_b32 v226, 0
    v_mov_b32 v227, 0
    v_mov_b32 v228, 0
    v_mov_b32 v229, 0
    v_mov_b32 v230, 0
    v_mov_b32 v231, 0
    v_mov_b32 v232, 0
    v_mov_b32 v233, 0
    v_mov_b32 v234, 0
    v_mov_b32 v235, 0
    v_mov_b32 v236, 0
    v_mov_b32 v237, 0
    v_mov_b32 v238, 0
    v_mov_b32 v239, 0
    v_mov_b32 v240, 0
    v_mov_b32 v241, 0
    v_mov_b32 v242, 0
    v_mov_b32 v243, 0
    v_mov_b32 v244, 0
    v_mov_b32 v245, 0
    v_mov_b32 v246, 0
    v_mov_b32 v247, 0
    v_mov_b32 v248, 0
    v_mov_b32 v249, 0
    v_mov_b32 v250, 0
    v_mov_b32 v251, 0
    v_mov_b32 v252, 0
    v_mov_b32 v253, 0
    v_mov_b32 v254, 0
    v_mov_b32 v255, 0
    s_waitcnt vmcnt(0)
    s_branch L_fin_b
L_fin_ld:
    s_waitcnt vmcnt(0)
L_fin_b:
    s_barrier
    s_cmp_lg_u32 s45, 0
    s_cbranch_scc1 L_noflag
    s_mov_b32 s48, s58
    v_mov_b32 v4, 1
    v_mov_b32 v5, 0
    s_mov_b64 exec, 1
    buffer_store_dword v4, v5, s[20:23], s48 offen sc1
    s_mov_b64 exec, -1
L_noflag:
    s_cmp_eq_u32 s3, 0
    s_cbranch_scc1 L_computeB
    s_mov_b32 s16, s8
    s_mov_b32 s17, s9
    s_add_u32 m0, s53, 147456
    s_movk_i32 s56, 512
    buffer_load_dwordx4 v28, s[16:19], s56 offen offset:0 lds
    buffer_load_dwordx4 v29, s[16:19], s56 offen offset:1024 lds
    buffer_load_dwordx4 v30, s[16:19], s56 offen offset:2048 lds
    buffer_load_dwordx4 v31, s[16:19], s56 offen offset:3072 lds
    s_add_u32 m0, s53, 0
    s_movk_i32 s56, 640
    buffer_load_dwordx4 v28, s[16:19], s56 offen offset:0 lds
    buffer_load_dwordx4 v29, s[16:19], s56 offen offset:1024 lds
    buffer_load_dwordx4 v30, s[16:19], s56 offen offset:2048 lds
    buffer_load_dwordx4 v31, s[16:19], s56 offen offset:3072 lds
    s_add_u32 m0, s53, 16384
    s_movk_i32 s56, 768
    buffer_load_dwordx4 v28, s[16:19], s56 offen offset:0 lds
    buffer_load_dwordx4 v29, s[16:19], s56 offen offset:1024 lds
    buffer_load_dwordx4 v30, s[16:19], s56 offen offset:2048 lds
    buffer_load_dwordx4 v31, s[16:19], s56 offen offset:3072 lds
    s_add_u32 m0, s53, 32768
    s_movk_i32 s56, 896
    buffer_load_dwordx4 v28, s[16:19], s56 offen offset:0 lds
    buffer_load_dwordx4 v29, s[16:19], s56 offen offset:1024 lds
    buffer_load_dwordx4 v30, s[16:19], s56 offen offset:2048 lds
    buffer_load_dwordx4 v31, s[16:19], s56 offen offset:3072 lds
    s_add_u32 m0, s53, 49152
    s_movk_i32 s56, 1024
    buffer_load_dwordx4 v28, s[16:19], s56 offen offset:0 lds
    buffer_load_dwordx4 v29, s[16:19], s56 offen offset:1024 lds
    buffer_load_dwordx4 v30, s[16:19], s56 offen offset:2048 lds
    buffer_load_dwordx4 v31, s[16:19], s56 offen offset:3072 lds
    s_add_u32 m0, s53, 65536
    s_movk_i32 s56, 1152
    buffer_load_dwordx4 v28, s[16:19], s56 offen offset:0 lds
    buffer_load_dwordx4 v29, s[16:19], s56 offen offset:1024 lds
    buffer_load_dwordx4 v30, s[16:19], s56 offen offset:2048 lds
    buffer_load_dwordx4 v31, s[16:19], s56 offen offset:3072 lds
    v_lshlrev_b32 v2, 4, v0
    v_add_u32 v2, s53, v2
    v_add_u32 v3, 0x10000, v2
    v_add_u32 v8, 0x20000, v2
    s_barrier
    s_waitcnt lgkmcnt(0)
    s_barrier
    ds_write_b128 v3, v[96:99] offset:16384
    ds_write_b128 v3, v[100:103] offset:17408
    ds_write_b128 v3, v[104:107] offset:18432
    ds_write_b128 v3, v[108:111] offset:19456
    s_waitcnt lgkmcnt(0)
    s_barrier
    ds_write_b128 v3, v[112:115] offset:32768
    ds_write_b128 v3, v[116:119] offset:33792
    ds_write_b128 v3, v[120:123] offset:34816
    ds_write_b128 v3, v[124:127] offset:35840
    s_waitcnt lgkmcnt(0)
    s_barrier
    ds_write_b128 v3, v[128:131] offset:49152
    ds_write_b128 v3, v[132:135] offset:50176
    ds_write_b128 v3, v[136:139] offset:51200
    ds_write_b128 v3, v[140:143] offset:52224
    s_waitcnt vmcnt(20) lgkmcnt(0)
    s_barrier
    ds_write_b128 v8, v[144:147] offset:0
    ds_write_b128 v8, v[148:151] offset:1024
    ds_write_b128 v8, v[152:155] offset:2048
    ds_write_b128 v8, v[156:159] offset:3072
    s_waitcnt vmcnt(16) lgkmcnt(0)
    s_barrier
    ds_write_b128 v8, v[160:163] offset:16384
    ds_write_b128 v8, v[164:167] offset:17408
    ds_write_b128 v8, v[168:171] offset:18432
    ds_write_b128 v8, v[172:175] offset:19456
    s_waitcnt vmcnt(12) lgkmcnt(0)
    s_barrier
    ds_write_b128 v2, v[176:179] offset:0
    ds_write_b128 v2, v[180:183] offset:1024
    ds_write_b128 v2, v[184:187] offset:2048
    ds_write_b128 v2, v[188:191] offset:3072
    s_waitcnt vmcnt(8) lgkmcnt(0)
    s_barrier
    ds_write_b128 v2, v[192:195] offset:16384
    ds_write_b128 v2, v[196:199] offset:17408
    ds_write_b128 v2, v[200:203] offset:18432
    ds_write_b128 v2, v[204:207] offset:19456
    s_waitcnt vmcnt(4) lgkmcnt(0)
    s_barrier
    s_mov_b32 s16, s10
    s_mov_b32 s17, s11
    s_add_u32 m0, s53, 32768
    s_movk_i32 s56, 128
    buffer_load_dwordx4 v28, s[16:19], s56 offen offset:0 lds
    buffer_load_dwordx4 v29, s[16:19], s56 offen offset:1024 lds
    buffer_load_dwordx4 v30, s[16:19], s56 offen offset:2048 lds
    buffer_load_dwordx4 v31, s[16:19], s56 offen offset:3072 lds
    s_waitcnt vmcnt(4) lgkmcnt(0)
    s_barrier
    s_mov_b32 s16, s10
    s_mov_b32 s17, s11
    s_add_u32 m0, s53, 49152
    s_movk_i32 s56, 256
    buffer_load_dwordx4 v28, s[16:19], s56 offen offset:0 lds
    buffer_load_dwordx4 v29, s[16:19], s56 offen offset:1024 lds
    buffer_load_dwordx4 v30, s[16:19], s56 offen offset:2048 lds
    buffer_load_dwordx4 v31, s[16:19], s56 offen offset:3072 lds
    s_waitcnt lgkmcnt(0)
    s_barrier
    s_mov_b32 s16, s10
    s_mov_b32 s17, s11
    s_add_u32 m0, s53, 65536
    s_movk_i32 s56, 384
    buffer_load_dwordx4 v28, s[16:19], s56 offen offset:0 lds
    buffer_load_dwordx4 v29, s[16:19], s56 offen offset:1024 lds
    buffer_load_dwordx4 v30, s[16:19], s56 offen offset:2048 lds
    buffer_load_dwordx4 v31, s[16:19], s56 offen offset:3072 lds
    s_waitcnt lgkmcnt(0)
    s_barrier
    s_mov_b32 s16, s10
    s_mov_b32 s17, s11
    s_add_u32 m0, s53, 81920
    s_movk_i32 s56, 512
    buffer_load_dwordx4 v28, s[16:19], s56 offen offset:0 lds
    buffer_load_dwordx4 v29, s[16:19], s56 offen offset:1024 lds
    buffer_load_dwordx4 v30, s[16:19], s56 offen offset:2048 lds
    buffer_load_dwordx4 v31, s[16:19], s56 offen offset:3072 lds
    s_waitcnt lgkmcnt(0)
    s_barrier
    s_mov_b32 s16, s10
    s_mov_b32 s17, s11
    s_add_u32 m0, s53, 98304
    s_movk_i32 s56, 640
    buffer_load_dwordx4 v28, s[16:19], s56 offen offset:0 lds
    buffer_load_dwordx4 v29, s[16:19], s56 offen offset:1024 lds
    buffer_load_dwordx4 v30, s[16:19], s56 offen offset:2048 lds
    buffer_load_dwordx4 v31, s[16:19], s56 offen offset:3072 lds
    s_waitcnt lgkmcnt(0)
    s_barrier
    s_mov_b32 s16, s10
    s_mov_b32 s17, s11
    s_add_u32 m0, s53, 114688
    s_movk_i32 s56, 768
    buffer_load_dwordx4 v28, s[16:19], s56 offen offset:0 lds
    buffer_load_dwordx4 v29, s[16:19], s56 offen offset:1024 lds
    buffer_load_dwordx4 v30, s[16:19], s56 offen offset:2048 lds
    buffer_load_dwordx4 v31, s[16:19], s56 offen offset:3072 lds
    s_waitcnt lgkmcnt(0)
    s_barrier
    s_mov_b32 s16, s10
    s_mov_b32 s17, s11
    s_add_u32 m0, s53, 131072
    s_movk_i32 s56, 896
    buffer_load_dwordx4 v28, s[16:19], s56 offen offset:0 lds
    buffer_load_dwordx4 v29, s[16:19], s56 offen offset:1024 lds
    buffer_load_dwordx4 v30, s[16:19], s56 offen offset:2048 lds
    buffer_load_dwordx4 v31, s[16:19], s56 offen offset:3072 lds
    s_waitcnt lgkmcnt(0)
    s_barrier
    s_mov_b32 s16, s10
    s_mov_b32 s17, s11
    s_add_u32 m0, s53, 147456
    s_movk_i32 s56, 1024
    buffer_load_dwordx4 v28, s[16:19], s56 offen offset:0 lds
    buffer_load_dwordx4 v29, s[16:19], s56 offen offset:1024 lds
    buffer_load_dwordx4 v30, s[16:19], s56 offen offset:2048 lds
    buffer_load_dwordx4 v31, s[16:19], s56 offen offset:3072 lds
    s_waitcnt lgkmcnt(0)
    s_barrier
    s_mov_b32 s16, s10
    s_mov_b32 s17, s11
    s_add_u32 m0, s53, 0
    s_movk_i32 s56, 1152
    buffer_load_dwordx4 v28, s[16:19], s56 offen offset:0 lds
    buffer_load_dwordx4 v29, s[16:19], s56 offen offset:1024 lds
    buffer_load_dwordx4 v30, s[16:19], s56 offen offset:2048 lds
    buffer_load_dwordx4 v31, s[16:19], s56 offen offset:3072 lds
    s_waitcnt vmcnt(32) lgkmcnt(0)
    s_barrier
    s_mov_b32 s16, s10
    s_mov_b32 s17, s11
    s_add_u32 m0, s53, 16384
    s_movk_i32 s56, 1280
    buffer_load_dwordx4 v28, s[16:19], s56 offen offset:0 lds
    buffer_load_dwordx4 v29, s[16:19], s56 offen offset:1024 lds
    buffer_load_dwordx4 v30, s[16:19], s56 offen offset:2048 lds
    buffer_load_dwordx4 v31, s[16:19], s56 offen offset:3072 lds
    s_waitcnt vmcnt(32) lgkmcnt(0)
    s_barrier
    s_mov_b32 s16, s10
    s_mov_b32 s17, s11
    s_add_u32 m0, s53, 32768
    s_movk_i32 s56, 1408
    buffer_load_dwordx4 v28, s[16:19], s56 offen offset:0 lds
    buffer_load_dwordx4 v29, s[16:19], s56 offen offset:1024 lds
    buffer_load_dwordx4 v30, s[16:19], s56 offen offset:2048 lds
    buffer_load_dwordx4 v31, s[16:19], s56 offen offset:3072 lds
    s_waitcnt vmcnt(32) lgkmcnt(0)
    s_barrier
    s_mov_b32 s16, s10
    s_mov_b32 s17, s11
    s_add_u32 m0, s53, 49152
    s_movk_i32 s56, 1536
    buffer_load_dwordx4 v28, s[16:19], s56 offen offset:0 lds
    buffer_load_dwordx4 v29, s[16:19], s56 offen offset:1024 lds
    buffer_load_dwordx4 v30, s[16:19], s56 offen offset:2048 lds
    buffer_load_dwordx4 v31, s[16:19], s56 offen offset:3072 lds
    s_waitcnt vmcnt(32) lgkmcnt(0)
    s_barrier
    s_mov_b32 s16, s10
    s_mov_b32 s17, s11
    s_add_u32 m0, s53, 65536
    s_movk_i32 s56, 1664
    buffer_load_dwordx4 v28, s[16:19], s56 offen offset:0 lds
    buffer_load_dwordx4 v29, s[16:19], s56 offen offset:1024 lds
    buffer_load_dwordx4 v30, s[16:19], s56 offen offset:2048 lds
    buffer_load_dwordx4 v31, s[16:19], s56 offen offset:3072 lds
    s_waitcnt vmcnt(32) lgkmcnt(0)
    s_barrier
    s_mov_b32 s16, s10
    s_mov_b32 s17, s11
    s_add_u32 m0, s53, 81920
    s_movk_i32 s56, 1792
    buffer_load_dwordx4 v28, s[16:19], s56 offen offset:0 lds
    buffer_load_dwordx4 v29, s[16:19], s56 offen offset:1024 lds
    buffer_load_dwordx4 v30, s[16:19], s56 offen offset:2048 lds
    buffer_load_dwordx4 v31, s[16:19], s56 offen offset:3072 lds
    s_waitcnt vmcnt(32) lgkmcnt(0)
    s_barrier
    s_mov_b32 s16, s10
    s_mov_b32 s17, s11
    s_add_u32 m0, s53, 98304
    s_movk_i32 s56, 1920
    buffer_load_dwordx4 v28, s[16:19], s56 offen offset:0 lds
    buffer_load_dwordx4 v29, s[16:19], s56 offen offset:1024 lds
    buffer_load_dwordx4 v30, s[16:19], s56 offen offset:2048 lds
    buffer_load_dwordx4 v31, s[16:19], s56 offen offset:3072 lds
    s_waitcnt vmcnt(32) lgkmcnt(0)
    s_barrier
    s_waitcnt vmcnt(28) lgkmcnt(0)
    s_barrier
    s_waitcnt vmcnt(24) lgkmcnt(0)
    s_barrier
    s_waitcnt vmcnt(20) lgkmcnt(0)
    s_barrier
    s_waitcnt vmcnt(16) lgkmcnt(0)
    s_barrier
    s_waitcnt vmcnt(12) lgkmcnt(0)
    s_barrier
    s_waitcnt vmcnt(8) lgkmcnt(0)
    s_barrier
    s_waitcnt vmcnt(4) lgkmcnt(0)
    s_barrier
    s_waitcnt vmcnt(0) lgkmcnt(0)
    s_barrier
    s_waitcnt lgkmcnt(0)
    s_barrier
    s_bfe_u32 s60, s2, 0x20001
    s_lshl_b32 s60, s60, 2
    s_bfe_u32 s62, s2, 0x20003
    s_add_u32 s60, s60, s62
    s_lshl_b32 s60, s60, 7
    s_and_b32 s62, s2, 1
    s_lshl_b32 s62, s62, 3
    s_lshr_b32 s63, s2, 5
    s_add_u32 s62, s62, s63
    s_lshl_b32 s62, s62, 6
    s_mov_b32 s24, s88
    s_mov_b32 s25, s89
    s_mov_b32 s26, 0x800000
    s_mov_b32 s27, 0x00020000
    v_lshrrev_b32 v2, 4, v0
    v_and_b32 v1, 15, v0
    s_lshr_b32 s48, s45, 2
    s_lshl_b32 s48, s48, 6
    s_and_b32 s49, s45, 3
    s_lshl_b32 s49, s49, 2
    s_add_u32 s48, s48, s49
    v_add_u32 v2, s48, v2
    v_mul_u32_u24 v3, 272, v2
    v_lshlrev_b32 v4, 4, v1
    v_add_u32 v3, v3, v4
    v_add_u32 v2, s60, v2
    v_lshlrev_b32 v2, 12, v2
    s_lshl_b32 s48, s62, 2
    v_add_u32 v4, s48, v4
    v_add_u32 v2, v2, v4
    s_barrier
    ds_read_b128 v[64:67], v3 offset:0
    ds_read_b128 v[68:71], v3 offset:34816
    s_waitcnt lgkmcnt(0)
    v_pk_add_f32 v[64:65], v[64:65], v[68:69]
    v_pk_add_f32 v[66:67], v[66:67], v[70:71]
    s_mov_b32 s50, 0
    buffer_store_dwordx4 v[64:67], v2, s[24:27], s50 offen sc1 nt
    s_barrier
    ds_read_b128 v[72:75], v3 offset:4352
    ds_read_b128 v[76:79], v3 offset:39168
    s_waitcnt lgkmcnt(0)
    v_pk_add_f32 v[72:73], v[72:73], v[76:77]
    v_pk_add_f32 v[74:75], v[74:75], v[78:79]
    s_mov_b32 s50, 65536
    buffer_store_dwordx4 v[72:75], v2, s[24:27], s50 offen sc1 nt
    s_barrier
    ds_read_b128 v[64:67], v3 offset:8704
    ds_read_b128 v[68:71], v3 offset:43520
    s_waitcnt lgkmcnt(0)
    v_pk_add_f32 v[64:65], v[64:65], v[68:69]
    v_pk_add_f32 v[66:67], v[66:67], v[70:71]
    s_mov_b32 s50, 131072
    buffer_store_dwordx4 v[64:67], v2, s[24:27], s50 offen sc1 nt
    s_barrier
    ds_read_b128 v[72:75], v3 offset:13056
    ds_read_b128 v[76:79], v3 offset:47872
    s_waitcnt lgkmcnt(0)
    v_pk_add_f32 v[72:73], v[72:73], v[76:77]
    v_pk_add_f32 v[74:75], v[74:75], v[78:79]
    s_mov_b32 s50, 196608
    buffer_store_dwordx4 v[72:75], v2, s[24:27], s50 offen sc1 nt
    s_branch L_end
L_computeB:
    s_lshr_b32 s48, s40, 8
    s_lshl_b32 s48, s48, 10
    s_add_u32 s48, s48, 16777728
    s_lshl_b32 s49, s46, 17
    s_add_u32 s48, s48, s49
    v_lshlrev_b32 v13, 13, v1
    s_mov_b32 s50, 131072
L_rdy_poll:
    buffer_load_dword v12, v13, s[20:23], s48 offen sc1
    s_waitcnt vmcnt(0)
    v_cmp_eq_u32 vcc, -1, v12
    s_cbranch_vccz L_rdy_ok
    s_sub_u32 s50, s50, 1
    s_cmp_eq_u32 s50, 0
    s_cbranch_scc1 L_rdy_ok
    s_branch L_rdy_poll
L_rdy_ok:
    s_mov_b32 s57, 0
    buffer_load_dwordx4 v[64:67], v20, s[20:23], s57 offen sc1
    buffer_load_dwordx4 v[68:71], v21, s[20:23], s57 offen sc1
    buffer_load_dwordx4 v[72:75], v8, s[20:23], s57 offen sc1
    buffer_load_dwordx4 v[76:79], v9, s[20:23], s57 offen sc1
    s_mov_b32 s57, 8192
    buffer_load_dwordx4 v[80:83], v20, s[20:23], s57 offen sc1
    buffer_load_dwordx4 v[84:87], v21, s[20:23], s57 offen sc1
    buffer_load_dwordx4 v[88:91], v8, s[20:23], s57 offen sc1
    buffer_load_dwordx4 v[92:95], v9, s[20:23], s57 offen sc1
    s_mov_b32 s57, 16384
    s_barrier
    ds_read_b128 v[32:35], v22 offset:0
    ds_read_b128 v[36:39], v22 offset:2048
    ds_read_b128 v[40:43], v22 offset:4096
    ds_read_b128 v[44:47], v22 offset:6144
    s_mov_b32 s59, 5
    s_mov_b32 s61, 4294819840
    s_mov_b32 s66, 16384
    s_waitcnt vmcnt(4) lgkmcnt(0)
    v_mfma_f32_16x16x32_bf16 v[192:195], v[32:35], v[64:67], v[192:195]
    ds_read_b128 v[48:51], v23 offset:0
    v_mfma_f32_16x16x32_bf16 v[196:199], v[32:35], v[68:71], v[196:199]
    ds_read_b128 v[52:55], v23 offset:2048
    v_mfma_f32_16x16x32_bf16 v[200:203], v[32:35], v[72:75], v[200:203]
    ds_read_b128 v[56:59], v23 offset:4096
    buffer_load_dwordx4 v[96:99], v20, s[20:23], s57 offen sc1
    v_mfma_f32_16x16x32_bf16 v[204:207], v[32:35], v[76:79], v[204:207]
    ds_read_b128 v[60:63], v23 offset:6144
    buffer_load_dwordx4 v[100:103], v21, s[20:23], s57 offen sc1
    v_mfma_f32_16x16x32_bf16 v[220:223], v[36:39], v[76:79], v[220:223]
    buffer_load_dwordx4 v[104:107], v8, s[20:23], s57 offen sc1
    v_mfma_f32_16x16x32_bf16 v[216:219], v[36:39], v[72:75], v[216:219]
    s_add_u32 s59, s59, 1
    v_mfma_f32_16x16x32_bf16 v[212:215], v[36:39], v[68:71], v[212:215]
    buffer_load_dwordx4 v[108:111], v9, s[20:23], s57 offen sc1
    v_mfma_f32_16x16x32_bf16 v[208:211], v[36:39], v[64:67], v[208:211]
    s_add_u32 s57, s57, 8192
    v_mfma_f32_16x16x32_bf16 v[224:227], v[40:43], v[64:67], v[224:227]
    buffer_load_dwordx4 v[112:115], v20, s[20:23], s57 offen sc1
    s_cmp_eq_u32 s59, 10
    v_mfma_f32_16x16x32_bf16 v[228:231], v[40:43], v[68:71], v[228:231]
    buffer_load_dwordx4 v[116:119], v21, s[20:23], s57 offen sc1
    s_cselect_b32 s60, s61, s66
    v_mfma_f32_16x16x32_bf16 v[232:235], v[40:43], v[72:75], v[232:235]
    buffer_load_dwordx4 v[120:123], v8, s[20:23], s57 offen sc1
    v_mfma_f32_16x16x32_bf16 v[236:239], v[40:43], v[76:79], v[236:239]
    s_cselect_b32 s59, 0, s59
    v_mfma_f32_16x16x32_bf16 v[252:255], v[44:47], v[76:79], v[252:255]
    buffer_load_dwordx4 v[124:127], v9, s[20:23], s57 offen sc1
    v_mfma_f32_16x16x32_bf16 v[248:251], v[44:47], v[72:75], v[248:251]
    s_add_u32 s57, s57, 8192
    v_mfma_f32_16x16x32_bf16 v[244:247], v[44:47], v[68:71], v[244:247]
    v_add_u32 v22, s60, v22
    v_mfma_f32_16x16x32_bf16 v[240:243], v[44:47], v[64:67], v[240:243]
    s_waitcnt vmcnt(8) lgkmcnt(0)
    v_mfma_f32_16x16x32_bf16 v[192:195], v[48:51], v[80:83], v[192:195]
    s_barrier
    v_mfma_f32_16x16x32_bf16 v[196:199], v[48:51], v[84:87], v[196:199]
    ds_read_b128 v[32:35], v22 offset:0
    v_mfma_f32_16x16x32_bf16 v[200:203], v[48:51], v[88:91], v[200:203]
    ds_read_b128 v[36:39], v22 offset:2048
    buffer_load_dwordx4 v[128:131], v20, s[20:23], s57 offen sc1
    v_mfma_f32_16x16x32_bf16 v[204:207], v[48:51], v[92:95], v[204:207]
    ds_read_b128 v[40:43], v22 offset:4096
    buffer_load_dwordx4 v[132:135], v21, s[20:23], s57 offen sc1
    v_mfma_f32_16x16x32_bf16 v[220:223], v[52:55], v[92:95], v[220:223]
    ds_read_b128 v[44:47], v22 offset:6144
    buffer_load_dwordx4 v[136:139], v8, s[20:23], s57 offen sc1
    v_mfma_f32_16x16x32_bf16 v[216:219], v[52:55], v[88:91], v[216:219]
    v_mfma_f32_16x16x32_bf16 v[212:215], v[52:55], v[84:87], v[212:215]
    buffer_load_dwordx4 v[140:143], v9, s[20:23], s57 offen sc1
    v_mfma_f32_16x16x32_bf16 v[208:211], v[52:55], v[80:83], v[208:211]
    s_add_u32 s57, s57, 8192
    v_mfma_f32_16x16x32_bf16 v[224:227], v[56:59], v[80:83], v[224:227]
    buffer_load_dwordx4 v[144:147], v20, s[20:23], s57 offen sc1
    v_mfma_f32_16x16x32_bf16 v[228:231], v[56:59], v[84:87], v[228:231]
    buffer_load_dwordx4 v[148:151], v21, s[20:23], s57 offen sc1
    v_mfma_f32_16x16x32_bf16 v[232:235], v[56:59], v[88:91], v[232:235]
    buffer_load_dwordx4 v[152:155], v8, s[20:23], s57 offen sc1
    v_mfma_f32_16x16x32_bf16 v[236:239], v[56:59], v[92:95], v[236:239]
    v_mfma_f32_16x16x32_bf16 v[252:255], v[60:63], v[92:95], v[252:255]
    buffer_load_dwordx4 v[156:159], v9, s[20:23], s57 offen sc1
    v_mfma_f32_16x16x32_bf16 v[248:251], v[60:63], v[88:91], v[248:251]
    s_add_u32 s57, s57, 8192
    v_mfma_f32_16x16x32_bf16 v[244:247], v[60:63], v[84:87], v[244:247]
    v_add_u32 v23, s60, v23
    v_mfma_f32_16x16x32_bf16 v[240:243], v[60:63], v[80:83], v[240:243]
    s_waitcnt vmcnt(12) lgkmcnt(0)
    v_mfma_f32_16x16x32_bf16 v[192:195], v[32:35], v[96:99], v[192:195]
    ds_read_b128 v[48:51], v23 offset:0
    v_mfma_f32_16x16x32_bf16 v[196:199], v[32:35], v[100:103], v[196:199]
    ds_read_b128 v[52:55], v23 offset:2048
    v_mfma_f32_16x16x32_bf16 v[200:203], v[32:35], v[104:107], v[200:203]
    ds_read_b128 v[56:59], v23 offset:4096
    buffer_load_dwordx4 v[64:67], v20, s[20:23], s57 offen sc1
    v_mfma_f32_16x16x32_bf16 v[204:207], v[32:35], v[108:111], v[204:207]
    ds_read_b128 v[60:63], v23 offset:6144
    buffer_load_dwordx4 v[68:71], v21, s[20:23], s57 offen sc1
    v_mfma_f32_16x16x32_bf16 v[220:223], v[36:39], v[108:111], v[220:223]
    buffer_load_dwordx4 v[72:75], v8, s[20:23], s57 offen sc1
    v_mfma_f32_16x16x32_bf16 v[216:219], v[36:39], v[104:107], v[216:219]
    s_add_u32 s59, s59, 1
    v_mfma_f32_16x16x32_bf16 v[212:215], v[36:39], v[100:103], v[212:215]
    buffer_load_dwordx4 v[76:79], v9, s[20:23], s57 offen sc1
    v_mfma_f32_16x16x32_bf16 v[208:211], v[36:39], v[96:99], v[208:211]
    s_add_u32 s57, s57, 8192
    v_mfma_f32_16x16x32_bf16 v[224:227], v[40:43], v[96:99], v[224:227]
    buffer_load_dwordx4 v[80:83], v20, s[20:23], s57 offen sc1
    s_cmp_eq_u32 s59, 10
    v_mfma_f32_16x16x32_bf16 v[228:231], v[40:43], v[100:103], v[228:231]
    buffer_load_dwordx4 v[84:87], v21, s[20:23], s57 offen sc1
    s_cselect_b32 s60, s61, s66
    v_mfma_f32_16x16x32_bf16 v[232:235], v[40:43], v[104:107], v[232:235]
    buffer_load_dwordx4 v[88:91], v8, s[20:23], s57 offen sc1
    v_mfma_f32_16x16x32_bf16 v[236:239], v[40:43], v[108:111], v[236:239]
    s_cselect_b32 s59, 0, s59
    v_mfma_f32_16x16x32_bf16 v[252:255], v[44:47], v[108:111], v[252:255]
    buffer_load_dwordx4 v[92:95], v9, s[20:23], s57 offen sc1
    v_mfma_f32_16x16x32_bf16 v[248:251], v[44:47], v[104:107], v[248:251]
    s_add_u32 s57, s57, 8192
    v_mfma_f32_16x16x32_bf16 v[244:247], v[44:47], v[100:103], v[244:247]
    v_add_u32 v22, s60, v22
    v_mfma_f32_16x16x32_bf16 v[240:243], v[44:47], v[96:99], v[240:243]
    s_waitcnt vmcnt(16) lgkmcnt(0)
    v_mfma_f32_16x16x32_bf16 v[192:195], v[48:51], v[112:115], v[192:195]
    s_barrier
    v_mfma_f32_16x16x32_bf16 v[196:199], v[48:51], v[116:119], v[196:199]
    ds_read_b128 v[32:35], v22 offset:0
    v_mfma_f32_16x16x32_bf16 v[200:203], v[48:51], v[120:123], v[200:203]
    ds_read_b128 v[36:39], v22 offset:2048
    v_mfma_f32_16x16x32_bf16 v[204:207], v[48:51], v[124:127], v[204:207]
    ds_read_b128 v[40:43], v22 offset:4096
    v_mfma_f32_16x16x32_bf16 v[220:223], v[52:55], v[124:127], v[220:223]
    ds_read_b128 v[44:47], v22 offset:6144
    v_mfma_f32_16x16x32_bf16 v[216:219], v[52:55], v[120:123], v[216:219]
    v_mfma_f32_16x16x32_bf16 v[212:215], v[52:55], v[116:119], v[212:215]
    buffer_load_dwordx4 v[96:99], v20, s[20:23], s57 offen sc1
    v_mfma_f32_16x16x32_bf16 v[208:211], v[52:55], v[112:115], v[208:211]
    v_mfma_f32_16x16x32_bf16 v[224:227], v[56:59], v[112:115], v[224:227]
    buffer_load_dwordx4 v[100:103], v21, s[20:23], s57 offen sc1
    v_mfma_f32_16x16x32_bf16 v[228:231], v[56:59], v[116:119], v[228:231]
    v_mfma_f32_16x16x32_bf16 v[232:235], v[56:59], v[120:123], v[232:235]
    buffer_load_dwordx4 v[104:107], v8, s[20:23], s57 offen sc1
    v_mfma_f32_16x16x32_bf16 v[236:239], v[56:59], v[124:127], v[236:239]
    v_mfma_f32_16x16x32_bf16 v[252:255], v[60:63], v[124:127], v[252:255]
    buffer_load_dwordx4 v[108:111], v9, s[20:23], s57 offen sc1
    v_mfma_f32_16x16x32_bf16 v[248:251], v[60:63], v[120:123], v[248:251]
    s_add_u32 s57, s57, 8192
    v_mfma_f32_16x16x32_bf16 v[244:247], v[60:63], v[116:119], v[244:247]
    v_add_u32 v23, s60, v23
    v_mfma_f32_16x16x32_bf16 v[240:243], v[60:63], v[112:115], v[240:243]
    s_waitcnt vmcnt(16) lgkmcnt(0)
    v_mfma_f32_16x16x32_bf16 v[192:195], v[32:35], v[128:131], v[192:195]
    ds_read_b128 v[48:51], v23 offset:0
    v_mfma_f32_16x16x32_bf16 v[196:199], v[32:35], v[132:135], v[196:199]
    ds_read_b128 v[52:55], v23 offset:2048
    v_mfma_f32_16x16x32_bf16 v[200:203], v[32:35], v[136:139], v[200:203]
    ds_read_b128 v[56:59], v23 offset:4096
    v_mfma_f32_16x16x32_bf16 v[204:207], v[32:35], v[140:143], v[204:207]
    ds_read_b128 v[60:63], v23 offset:6144
    v_mfma_f32_16x16x32_bf16 v[220:223], v[36:39], v[140:143], v[220:223]
    v_mfma_f32_16x16x32_bf16 v[216:219], v[36:39], v[136:139], v[216:219]
    s_add_u32 s59, s59, 1
    v_mfma_f32_16x16x32_bf16 v[212:215], v[36:39], v[132:135], v[212:215]
    buffer_load_dwordx4 v[112:115], v20, s[20:23], s57 offen sc1
    v_mfma_f32_16x16x32_bf16 v[208:211], v[36:39], v[128:131], v[208:211]
    v_mfma_f32_16x16x32_bf16 v[224:227], v[40:43], v[128:131], v[224:227]
    buffer_load_dwordx4 v[116:119], v21, s[20:23], s57 offen sc1
    s_cmp_eq_u32 s59, 10
    v_mfma_f32_16x16x32_bf16 v[228:231], v[40:43], v[132:135], v[228:231]
    s_cselect_b32 s60, s61, s66
    v_mfma_f32_16x16x32_bf16 v[232:235], v[40:43], v[136:139], v[232:235]
    buffer_load_dwordx4 v[120:123], v8, s[20:23], s57 offen sc1
    v_mfma_f32_16x16x32_bf16 v[236:239], v[40:43], v[140:143], v[236:239]
    s_cselect_b32 s59, 0, s59
    v_mfma_f32_16x16x32_bf16 v[252:255], v[44:47], v[140:143], v[252:255]
    buffer_load_dwordx4 v[124:127], v9, s[20:23], s57 offen sc1
    v_mfma_f32_16x16x32_bf16 v[248:251], v[44:47], v[136:139], v[248:251]
    s_add_u32 s57, s57, 8192
    v_mfma_f32_16x16x32_bf16 v[244:247], v[44:47], v[132:135], v[244:247]
    v_add_u32 v22, s60, v22
    v_mfma_f32_16x16x32_bf16 v[240:243], v[44:47], v[128:131], v[240:243]
    s_waitcnt vmcnt(16) lgkmcnt(0)
    v_mfma_f32_16x16x32_bf16 v[192:195], v[48:51], v[144:147], v[192:195]
    s_barrier
    v_mfma_f32_16x16x32_bf16 v[196:199], v[48:51], v[148:151], v[196:199]
    ds_read_b128 v[32:35], v22 offset:0
    v_mfma_f32_16x16x32_bf16 v[200:203], v[48:51], v[152:155], v[200:203]
    ds_read_b128 v[36:39], v22 offset:2048
    v_mfma_f32_16x16x32_bf16 v[204:207], v[48:51], v[156:159], v[204:207]
    ds_read_b128 v[40:43], v22 offset:4096
    v_mfma_f32_16x16x32_bf16 v[220:223], v[52:55], v[156:159], v[220:223]
    ds_read_b128 v[44:47], v22 offset:6144
    v_mfma_f32_16x16x32_bf16 v[216:219], v[52:55], v[152:155], v[216:219]
    v_mfma_f32_16x16x32_bf16 v[212:215], v[52:55], v[148:151], v[212:215]
    buffer_load_dwordx4 v[128:131], v20, s[20:23], s57 offen sc1
    v_mfma_f32_16x16x32_bf16 v[208:211], v[52:55], v[144:147], v[208:211]
    v_mfma_f32_16x16x32_bf16 v[224:227], v[56:59], v[144:147], v[224:227]
    buffer_load_dwordx4 v[132:135], v21, s[20:23], s57 offen sc1
    v_mfma_f32_16x16x32_bf16 v[228:231], v[56:59], v[148:151], v[228:231]
    v_mfma_f32_16x16x32_bf16 v[232:235], v[56:59], v[152:155], v[232:235]
    buffer_load_dwordx4 v[136:139], v8, s[20:23], s57 offen sc1
    v_mfma_f32_16x16x32_bf16 v[236:239], v[56:59], v[156:159], v[236:239]
    v_mfma_f32_16x16x32_bf16 v[252:255], v[60:63], v[156:159], v[252:255]
    buffer_load_dwordx4 v[140:143], v9, s[20:23], s57 offen sc1
    v_mfma_f32_16x16x32_bf16 v[248:251], v[60:63], v[152:155], v[248:251]
    s_add_u32 s57, s57, 8192
    v_mfma_f32_16x16x32_bf16 v[244:247], v[60:63], v[148:151], v[244:247]
    v_add_u32 v23, s60, v23
    v_mfma_f32_16x16x32_bf16 v[240:243], v[60:63], v[144:147], v[240:243]
    s_mov_b32 s58, 9
L_cB_loop:
    s_waitcnt vmcnt(16) lgkmcnt(0)
    v_mfma_f32_16x16x32_bf16 v[192:195], v[32:35], v[64:67], v[192:195]
    ds_read_b128 v[48:51], v23 offset:0
    v_mfma_f32_16x16x32_bf16 v[196:199], v[32:35], v[68:71], v[196:199]
    ds_read_b128 v[52:55], v23 offset:2048
    v_mfma_f32_16x16x32_bf16 v[200:203], v[32:35], v[72:75], v[200:203]
    ds_read_b128 v[56:59], v23 offset:4096
    v_mfma_f32_16x16x32_bf16 v[204:207], v[32:35], v[76:79], v[204:207]
    ds_read_b128 v[60:63], v23 offset:6144
    v_mfma_f32_16x16x32_bf16 v[220:223], v[36:39], v[76:79], v[220:223]
    v_mfma_f32_16x16x32_bf16 v[216:219], v[36:39], v[72:75], v[216:219]
    s_add_u32 s59, s59, 1
    v_mfma_f32_16x16x32_bf16 v[212:215], v[36:39], v[68:71], v[212:215]
    buffer_load_dwordx4 v[144:147], v20, s[20:23], s57 offen sc1
    v_mfma_f32_16x16x32_bf16 v[208:211], v[36:39], v[64:67], v[208:211]
    v_mfma_f32_16x16x32_bf16 v[224:227], v[40:43], v[64:67], v[224:227]
    buffer_load_dwordx4 v[148:151], v21, s[20:23], s57 offen sc1
    s_cmp_eq_u32 s59, 10
    v_mfma_f32_16x16x32_bf16 v[228:231], v[40:43], v[68:71], v[228:231]
    s_cselect_b32 s60, s61, s66
    v_mfma_f32_16x16x32_bf16 v[232:235], v[40:43], v[72:75], v[232:235]
    buffer_load_dwordx4 v[152:155], v8, s[20:23], s57 offen sc1
    v_mfma_f32_16x16x32_bf16 v[236:239], v[40:43], v[76:79], v[236:239]
    s_cselect_b32 s59, 0, s59
    v_mfma_f32_16x16x32_bf16 v[252:255], v[44:47], v[76:79], v[252:255]
    buffer_load_dwordx4 v[156:159], v9, s[20:23], s57 offen sc1
    v_mfma_f32_16x16x32_bf16 v[248:251], v[44:47], v[72:75], v[248:251]
    s_add_u32 s57, s57, 8192
    v_mfma_f32_16x16x32_bf16 v[244:247], v[44:47], v[68:71], v[244:247]
    v_add_u32 v22, s60, v22
    v_mfma_f32_16x16x32_bf16 v[240:243], v[44:47], v[64:67], v[240:243]
    s_waitcnt vmcnt(16) lgkmcnt(0)
    v_mfma_f32_16x16x32_bf16 v[192:195], v[48:51], v[80:83], v[192:195]
    s_barrier
    v_mfma_f32_16x16x32_bf16 v[196:199], v[48:51], v[84:87], v[196:199]
    ds_read_b128 v[32:35], v22 offset:0
    v_mfma_f32_16x16x32_bf16 v[200:203], v[48:51], v[88:91], v[200:203]
    ds_read_b128 v[36:39], v22 offset:2048
    v_mfma_f32_16x16x32_bf16 v[204:207], v[48:51], v[92:95], v[204:207]
    ds_read_b128 v[40:43], v22 offset:4096
    v_mfma_f32_16x16x32_bf16 v[220:223], v[52:55], v[92:95], v[220:223]
    ds_read_b128 v[44:47], v22 offset:6144
    v_mfma_f32_16x16x32_bf16 v[216:219], v[52:55], v[88:91], v[216:219]
    v_mfma_f32_16x16x32_bf16 v[212:215], v[52:55], v[84:87], v[212:215]
    buffer_load_dwordx4 v[64:67], v20, s[20:23], s57 offen sc1
    v_mfma_f32_16x16x32_bf16 v[208:211], v[52:55], v[80:83], v[208:211]
    v_mfma_f32_16x16x32_bf16 v[224:227], v[56:59], v[80:83], v[224:227]
    buffer_load_dwordx4 v[68:71], v21, s[20:23], s57 offen sc1
    v_mfma_f32_16x16x32_bf16 v[228:231], v[56:59], v[84:87], v[228:231]
    v_mfma_f32_16x16x32_bf16 v[232:235], v[56:59], v[88:91], v[232:235]
    buffer_load_dwordx4 v[72:75], v8, s[20:23], s57 offen sc1
    v_mfma_f32_16x16x32_bf16 v[236:239], v[56:59], v[92:95], v[236:239]
    v_mfma_f32_16x16x32_bf16 v[252:255], v[60:63], v[92:95], v[252:255]
    buffer_load_dwordx4 v[76:79], v9, s[20:23], s57 offen sc1
    v_mfma_f32_16x16x32_bf16 v[248:251], v[60:63], v[88:91], v[248:251]
    s_add_u32 s57, s57, 8192
    v_mfma_f32_16x16x32_bf16 v[244:247], v[60:63], v[84:87], v[244:247]
    v_add_u32 v23, s60, v23
    v_mfma_f32_16x16x32_bf16 v[240:243], v[60:63], v[80:83], v[240:243]
    s_waitcnt vmcnt(16) lgkmcnt(0)
    v_mfma_f32_16x16x32_bf16 v[192:195], v[32:35], v[96:99], v[192:195]
    ds_read_b128 v[48:51], v23 offset:0
    v_mfma_f32_16x16x32_bf16 v[196:199], v[32:35], v[100:103], v[196:199]
    ds_read_b128 v[52:55], v23 offset:2048
    v_mfma_f32_16x16x32_bf16 v[200:203], v[32:35], v[104:107], v[200:203]
    ds_read_b128 v[56:59], v23 offset:4096
    v_mfma_f32_16x16x32_bf16 v[204:207], v[32:35], v[108:111], v[204:207]
    ds_read_b128 v[60:63], v23 offset:6144
    v_mfma_f32_16x16x32_bf16 v[220:223], v[36:39], v[108:111], v[220:223]
    v_mfma_f32_16x16x32_bf16 v[216:219], v[36:39], v[104:107], v[216:219]
    s_add_u32 s59, s59, 1
    v_mfma_f32_16x16x32_bf16 v[212:215], v[36:39], v[100:103], v[212:215]
    buffer_load_dwordx4 v[80:83], v20, s[20:23], s57 offen sc1
    v_mfma_f32_16x16x32_bf16 v[208:211], v[36:39], v[96:99], v[208:211]
    v_mfma_f32_16x16x32_bf16 v[224:227], v[40:43], v[96:99], v[224:227]
    buffer_load_dwordx4 v[84:87], v21, s[20:23], s57 offen sc1
    s_cmp_eq_u32 s59, 10
    v_mfma_f32_16x16x32_bf16 v[228:231], v[40:43], v[100:103], v[228:231]
    s_cselect_b32 s60, s61, s66
    v_mfma_f32_16x16x32_bf16 v[232:235], v[40:43], v[104:107], v[232:235]
    buffer_load_dwordx4 v[88:91], v8, s[20:23], s57 offen sc1
    v_mfma_f32_16x16x32_bf16 v[236:239], v[40:43], v[108:111], v[236:239]
    s_cselect_b32 s59, 0, s59
    v_mfma_f32_16x16x32_bf16 v[252:255], v[44:47], v[108:111], v[252:255]
    buffer_load_dwordx4 v[92:95], v9, s[20:23], s57 offen sc1
    v_mfma_f32_16x16x32_bf16 v[248:251], v[44:47], v[104:107], v[248:251]
    s_add_u32 s57, s57, 8192
    v_mfma_f32_16x16x32_bf16 v[244:247], v[44:47], v[100:103], v[244:247]
    v_add_u32 v22, s60, v22
    v_mfma_f32_16x16x32_bf16 v[240:243], v[44:47], v[96:99], v[240:243]
    s_waitcnt vmcnt(16) lgkmcnt(0)
    v_mfma_f32_16x16x32_bf16 v[192:195], v[48:51], v[112:115], v[192:195]
    s_barrier
    v_mfma_f32_16x16x32_bf16 v[196:199], v[48:51], v[116:119], v[196:199]
    ds_read_b128 v[32:35], v22 offset:0
    v_mfma_f32_16x16x32_bf16 v[200:203], v[48:51], v[120:123], v[200:203]
    ds_read_b128 v[36:39], v22 offset:2048
    v_mfma_f32_16x16x32_bf16 v[204:207], v[48:51], v[124:127], v[204:207]
    ds_read_b128 v[40:43], v22 offset:4096
    v_mfma_f32_16x16x32_bf16 v[220:223], v[52:55], v[124:127], v[220:223]
    ds_read_b128 v[44:47], v22 offset:6144
    v_mfma_f32_16x16x32_bf16 v[216:219], v[52:55], v[120:123], v[216:219]
    v_mfma_f32_16x16x32_bf16 v[212:215], v[52:55], v[116:119], v[212:215]
    buffer_load_dwordx4 v[96:99], v20, s[20:23], s57 offen sc1
    v_mfma_f32_16x16x32_bf16 v[208:211], v[52:55], v[112:115], v[208:211]
    v_mfma_f32_16x16x32_bf16 v[224:227], v[56:59], v[112:115], v[224:227]
    buffer_load_dwordx4 v[100:103], v21, s[20:23], s57 offen sc1
    v_mfma_f32_16x16x32_bf16 v[228:231], v[56:59], v[116:119], v[228:231]
    v_mfma_f32_16x16x32_bf16 v[232:235], v[56:59], v[120:123], v[232:235]
    buffer_load_dwordx4 v[104:107], v8, s[20:23], s57 offen sc1
    v_mfma_f32_16x16x32_bf16 v[236:239], v[56:59], v[124:127], v[236:239]
    v_mfma_f32_16x16x32_bf16 v[252:255], v[60:63], v[124:127], v[252:255]
    buffer_load_dwordx4 v[108:111], v9, s[20:23], s57 offen sc1
    v_mfma_f32_16x16x32_bf16 v[248:251], v[60:63], v[120:123], v[248:251]
    s_add_u32 s57, s57, 8192
    v_mfma_f32_16x16x32_bf16 v[244:247], v[60:63], v[116:119], v[244:247]
    v_add_u32 v23, s60, v23
    v_mfma_f32_16x16x32_bf16 v[240:243], v[60:63], v[112:115], v[240:243]
    s_waitcnt vmcnt(16) lgkmcnt(0)
    v_mfma_f32_16x16x32_bf16 v[192:195], v[32:35], v[128:131], v[192:195]
    ds_read_b128 v[48:51], v23 offset:0
    v_mfma_f32_16x16x32_bf16 v[196:199], v[32:35], v[132:135], v[196:199]
    ds_read_b128 v[52:55], v23 offset:2048
    v_mfma_f32_16x16x32_bf16 v[200:203], v[32:35], v[136:139], v[200:203]
    ds_read_b128 v[56:59], v23 offset:4096
    v_mfma_f32_16x16x32_bf16 v[204:207], v[32:35], v[140:143], v[204:207]
    ds_read_b128 v[60:63], v23 offset:6144
    v_mfma_f32_16x16x32_bf16 v[220:223], v[36:39], v[140:143], v[220:223]
    v_mfma_f32_16x16x32_bf16 v[216:219], v[36:39], v[136:139], v[216:219]
    s_add_u32 s59, s59, 1
    v_mfma_f32_16x16x32_bf16 v[212:215], v[36:39], v[132:135], v[212:215]
    buffer_load_dwordx4 v[112:115], v20, s[20:23], s57 offen sc1
    v_mfma_f32_16x16x32_bf16 v[208:211], v[36:39], v[128:131], v[208:211]
    v_mfma_f32_16x16x32_bf16 v[224:227], v[40:43], v[128:131], v[224:227]
    buffer_load_dwordx4 v[116:119], v21, s[20:23], s57 offen sc1
    s_cmp_eq_u32 s59, 10
    v_mfma_f32_16x16x32_bf16 v[228:231], v[40:43], v[132:135], v[228:231]
    s_cselect_b32 s60, s61, s66
    v_mfma_f32_16x16x32_bf16 v[232:235], v[40:43], v[136:139], v[232:235]
    buffer_load_dwordx4 v[120:123], v8, s[20:23], s57 offen sc1
    v_mfma_f32_16x16x32_bf16 v[236:239], v[40:43], v[140:143], v[236:239]
    s_cselect_b32 s59, 0, s59
    v_mfma_f32_16x16x32_bf16 v[252:255], v[44:47], v[140:143], v[252:255]
    buffer_load_dwordx4 v[124:127], v9, s[20:23], s57 offen sc1
    v_mfma_f32_16x16x32_bf16 v[248:251], v[44:47], v[136:139], v[248:251]
    s_add_u32 s57, s57, 8192
    v_mfma_f32_16x16x32_bf16 v[244:247], v[44:47], v[132:135], v[244:247]
    v_add_u32 v22, s60, v22
    v_mfma_f32_16x16x32_bf16 v[240:243], v[44:47], v[128:131], v[240:243]
    s_waitcnt vmcnt(16) lgkmcnt(0)
    v_mfma_f32_16x16x32_bf16 v[192:195], v[48:51], v[144:147], v[192:195]
    s_barrier
    v_mfma_f32_16x16x32_bf16 v[196:199], v[48:51], v[148:151], v[196:199]
    ds_read_b128 v[32:35], v22 offset:0
    v_mfma_f32_16x16x32_bf16 v[200:203], v[48:51], v[152:155], v[200:203]
    ds_read_b128 v[36:39], v22 offset:2048
    v_mfma_f32_16x16x32_bf16 v[204:207], v[48:51], v[156:159], v[204:207]
    ds_read_b128 v[40:43], v22 offset:4096
    v_mfma_f32_16x16x32_bf16 v[220:223], v[52:55], v[156:159], v[220:223]
    ds_read_b128 v[44:47], v22 offset:6144
    v_mfma_f32_16x16x32_bf16 v[216:219], v[52:55], v[152:155], v[216:219]
    v_mfma_f32_16x16x32_bf16 v[212:215], v[52:55], v[148:151], v[212:215]
    buffer_load_dwordx4 v[128:131], v20, s[20:23], s57 offen sc1
    v_mfma_f32_16x16x32_bf16 v[208:211], v[52:55], v[144:147], v[208:211]
    v_mfma_f32_16x16x32_bf16 v[224:227], v[56:59], v[144:147], v[224:227]
    buffer_load_dwordx4 v[132:135], v21, s[20:23], s57 offen sc1
    v_mfma_f32_16x16x32_bf16 v[228:231], v[56:59], v[148:151], v[228:231]
    v_mfma_f32_16x16x32_bf16 v[232:235], v[56:59], v[152:155], v[232:235]
    buffer_load_dwordx4 v[136:139], v8, s[20:23], s57 offen sc1
    v_mfma_f32_16x16x32_bf16 v[236:239], v[56:59], v[156:159], v[236:239]
    v_mfma_f32_16x16x32_bf16 v[252:255], v[60:63], v[156:159], v[252:255]
    buffer_load_dwordx4 v[140:143], v9, s[20:23], s57 offen sc1
    v_mfma_f32_16x16x32_bf16 v[248:251], v[60:63], v[152:155], v[248:251]
    s_add_u32 s57, s57, 8192
    v_mfma_f32_16x16x32_bf16 v[244:247], v[60:63], v[148:151], v[244:247]
    v_add_u32 v23, s60, v23
    v_mfma_f32_16x16x32_bf16 v[240:243], v[60:63], v[144:147], v[240:243]
    s_sub_u32 s58, s58, 1
    s_cmp_lg_u32 s58, 0
    s_cbranch_scc1 L_cB_loop
    s_mov_b32 s51, 17039360
    buffer_load_dword v24, v7, s[20:23], s51 offen offset:0 sc1
    buffer_load_dword v25, v7, s[20:23], s51 offen offset:128 sc1
    buffer_load_dword v26, v7, s[20:23], s51 offen offset:256 sc1
    buffer_load_dword v27, v7, s[20:23], s51 offen offset:384 sc1
    s_bfe_u32 s60, s2, 0x20001
    s_lshl_b32 s60, s60, 2
    s_bfe_u32 s62, s2, 0x20003
    s_add_u32 s60, s60, s62
    s_lshl_b32 s60, s60, 7
    s_and_b32 s62, s2, 1
    s_lshl_b32 s62, s62, 3
    s_lshr_b32 s63, s2, 5
    s_add_u32 s62, s62, s63
    s_lshl_b32 s62, s62, 6
    s_mov_b32 s24, s88
    s_mov_b32 s25, s89
    s_mov_b32 s26, 0x800000
    s_mov_b32 s27, 0x00020000
    v_lshrrev_b32 v2, 4, v0
    v_and_b32 v1, 15, v0
    s_lshr_b32 s48, s45, 2
    s_lshl_b32 s48, s48, 6
    s_and_b32 s49, s45, 3
    s_lshl_b32 s49, s49, 2
    s_add_u32 s48, s48, s49
    v_add_u32 v2, s48, v2
    v_mul_u32_u24 v3, 272, v2
    v_lshlrev_b32 v4, 4, v1
    v_add_u32 v3, v3, v4
    v_add_u32 v2, s60, v2
    v_lshlrev_b32 v2, 12, v2
    s_lshl_b32 s48, s62, 2
    v_add_u32 v4, s48, v4
    v_add_u32 v2, v2, v4
    s_waitcnt vmcnt(20) lgkmcnt(0)
    v_mfma_f32_16x16x32_bf16 v[192:195], v[32:35], v[64:67], v[192:195]
    ds_read_b128 v[48:51], v23 offset:0
    v_mfma_f32_16x16x32_bf16 v[196:199], v[32:35], v[68:71], v[196:199]
    ds_read_b128 v[52:55], v23 offset:2048
    v_mfma_f32_16x16x32_bf16 v[200:203], v[32:35], v[72:75], v[200:203]
    ds_read_b128 v[56:59], v23 offset:4096
    v_mfma_f32_16x16x32_bf16 v[204:207], v[32:35], v[76:79], v[204:207]
    ds_read_b128 v[60:63], v23 offset:6144
    v_mfma_f32_16x16x32_bf16 v[220:223], v[36:39], v[76:79], v[220:223]
    v_mfma_f32_16x16x32_bf16 v[216:219], v[36:39], v[72:75], v[216:219]
    s_add_u32 s59, s59, 1
    v_mfma_f32_16x16x32_bf16 v[212:215], v[36:39], v[68:71], v[212:215]
    v_mfma_f32_16x16x32_bf16 v[208:211], v[36:39], v[64:67], v[208:211]
    v_mfma_f32_16x16x32_bf16 v[224:227], v[40:43], v[64:67], v[224:227]
    s_cmp_eq_u32 s59, 10
    v_mfma_f32_16x16x32_bf16 v[228:231], v[40:43], v[68:71], v[228:231]
    s_cselect_b32 s60, s61, s66
    v_mfma_f32_16x16x32_bf16 v[232:235], v[40:43], v[72:75], v[232:235]
    v_mfma_f32_16x16x32_bf16 v[236:239], v[40:43], v[76:79], v[236:239]
    s_cselect_b32 s59, 0, s59
    v_mfma_f32_16x16x32_bf16 v[252:255], v[44:47], v[76:79], v[252:255]
    v_mfma_f32_16x16x32_bf16 v[248:251], v[44:47], v[72:75], v[248:251]
    v_mfma_f32_16x16x32_bf16 v[244:247], v[44:47], v[68:71], v[244:247]
    v_add_u32 v22, s60, v22
    v_mfma_f32_16x16x32_bf16 v[240:243], v[44:47], v[64:67], v[240:243]
    s_waitcnt vmcnt(16) lgkmcnt(0)
    v_mfma_f32_16x16x32_bf16 v[192:195], v[48:51], v[80:83], v[192:195]
    s_barrier
    v_mfma_f32_16x16x32_bf16 v[196:199], v[48:51], v[84:87], v[196:199]
    ds_read_b128 v[32:35], v22 offset:0
    v_mfma_f32_16x16x32_bf16 v[200:203], v[48:51], v[88:91], v[200:203]
    ds_read_b128 v[36:39], v22 offset:2048
    v_mfma_f32_16x16x32_bf16 v[204:207], v[48:51], v[92:95], v[204:207]
    ds_read_b128 v[40:43], v22 offset:4096
    v_mfma_f32_16x16x32_bf16 v[220:223], v[52:55], v[92:95], v[220:223]
    ds_read_b128 v[44:47], v22 offset:6144
    v_mfma_f32_16x16x32_bf16 v[216:219], v[52:55], v[88:91], v[216:219]
    v_mfma_f32_16x16x32_bf16 v[212:215], v[52:55], v[84:87], v[212:215]
    v_mfma_f32_16x16x32_bf16 v[208:211], v[52:55], v[80:83], v[208:211]
    v_mfma_f32_16x16x32_bf16 v[224:227], v[56:59], v[80:83], v[224:227]
    v_mfma_f32_16x16x32_bf16 v[228:231], v[56:59], v[84:87], v[228:231]
    v_mfma_f32_16x16x32_bf16 v[232:235], v[56:59], v[88:91], v[232:235]
    v_mfma_f32_16x16x32_bf16 v[236:239], v[56:59], v[92:95], v[236:239]
    v_mfma_f32_16x16x32_bf16 v[252:255], v[60:63], v[92:95], v[252:255]
    v_mfma_f32_16x16x32_bf16 v[248:251], v[60:63], v[88:91], v[248:251]
    v_mfma_f32_16x16x32_bf16 v[244:247], v[60:63], v[84:87], v[244:247]
    v_add_u32 v23, s60, v23
    v_mfma_f32_16x16x32_bf16 v[240:243], v[60:63], v[80:83], v[240:243]
    s_waitcnt vmcnt(12) lgkmcnt(0)
    v_mfma_f32_16x16x32_bf16 v[192:195], v[32:35], v[96:99], v[192:195]
    ds_read_b128 v[48:51], v23 offset:0
    v_mfma_f32_16x16x32_bf16 v[196:199], v[32:35], v[100:103], v[196:199]
    ds_read_b128 v[52:55], v23 offset:2048
    v_mfma_f32_16x16x32_bf16 v[200:203], v[32:35], v[104:107], v[200:203]
    ds_read_b128 v[56:59], v23 offset:4096
    v_mfma_f32_16x16x32_bf16 v[204:207], v[32:35], v[108:111], v[204:207]
    ds_read_b128 v[60:63], v23 offset:6144
    v_mfma_f32_16x16x32_bf16 v[220:223], v[36:39], v[108:111], v[220:223]
    v_mfma_f32_16x16x32_bf16 v[216:219], v[36:39], v[104:107], v[216:219]
    s_add_u32 s59, s59, 1
    v_mfma_f32_16x16x32_bf16 v[212:215], v[36:39], v[100:103], v[212:215]
    v_mfma_f32_16x16x32_bf16 v[208:211], v[36:39], v[96:99], v[208:211]
    v_mfma_f32_16x16x32_bf16 v[224:227], v[40:43], v[96:99], v[224:227]
    s_cmp_eq_u32 s59, 10
    v_mfma_f32_16x16x32_bf16 v[228:231], v[40:43], v[100:103], v[228:231]
    s_cselect_b32 s60, s61, s66
    v_mfma_f32_16x16x32_bf16 v[232:235], v[40:43], v[104:107], v[232:235]
    v_mfma_f32_16x16x32_bf16 v[236:239], v[40:43], v[108:111], v[236:239]
    s_cselect_b32 s59, 0, s59
    v_mfma_f32_16x16x32_bf16 v[252:255], v[44:47], v[108:111], v[252:255]
    v_mfma_f32_16x16x32_bf16 v[248:251], v[44:47], v[104:107], v[248:251]
    v_mfma_f32_16x16x32_bf16 v[244:247], v[44:47], v[100:103], v[244:247]
    v_add_u32 v22, s60, v22
    v_mfma_f32_16x16x32_bf16 v[240:243], v[44:47], v[96:99], v[240:243]
    s_waitcnt vmcnt(8) lgkmcnt(0)
    v_mfma_f32_16x16x32_bf16 v[192:195], v[48:51], v[112:115], v[192:195]
    s_barrier
    v_mfma_f32_16x16x32_bf16 v[208:211], v[52:55], v[112:115], v[208:211]
    v_mfma_f32_16x16x32_bf16 v[224:227], v[56:59], v[112:115], v[224:227]
    v_mfma_f32_16x16x32_bf16 v[240:243], v[60:63], v[112:115], v[240:243]
    v_mfma_f32_16x16x32_bf16 v[196:199], v[48:51], v[116:119], v[196:199]
    v_mfma_f32_16x16x32_bf16 v[212:215], v[52:55], v[116:119], v[212:215]
    v_mfma_f32_16x16x32_bf16 v[228:231], v[56:59], v[116:119], v[228:231]
    v_mfma_f32_16x16x32_bf16 v[244:247], v[60:63], v[116:119], v[244:247]
    v_mfma_f32_16x16x32_bf16 v[200:203], v[48:51], v[120:123], v[200:203]
    v_mfma_f32_16x16x32_bf16 v[216:219], v[52:55], v[120:123], v[216:219]
    v_mfma_f32_16x16x32_bf16 v[232:235], v[56:59], v[120:123], v[232:235]
    v_mfma_f32_16x16x32_bf16 v[248:251], v[60:63], v[120:123], v[248:251]
    v_mfma_f32_16x16x32_bf16 v[204:207], v[48:51], v[124:127], v[204:207]
    v_mfma_f32_16x16x32_bf16 v[220:223], v[52:55], v[124:127], v[220:223]
    v_mfma_f32_16x16x32_bf16 v[236:239], v[56:59], v[124:127], v[236:239]
    v_add_u32 v23, s60, v23
    v_mfma_f32_16x16x32_bf16 v[252:255], v[60:63], v[124:127], v[252:255]
    s_waitcnt vmcnt(0)
    v_lshlrev_b32 v96, 16, v160
    v_and_b32 v97, 0xffff0000, v160
    v_lshlrev_b32 v98, 16, v161
    v_and_b32 v99, 0xffff0000, v161
    v_pk_add_f32 v[192:193], v[192:193], v[96:97]
    v_pk_add_f32 v[194:195], v[194:195], v[98:99]
    v_pk_mul_f32 v[192:193], v[24:25], v[192:193] op_sel:[0,0] op_sel_hi:[0,1]
    v_pk_mul_f32 v[194:195], v[24:25], v[194:195] op_sel:[0,0] op_sel_hi:[0,1]
    ds_write_b128 v11, v[192:195] offset:0
    v_lshlrev_b32 v100, 16, v162
    v_and_b32 v101, 0xffff0000, v162
    v_lshlrev_b32 v102, 16, v163
    v_and_b32 v103, 0xffff0000, v163
    v_pk_add_f32 v[208:209], v[208:209], v[100:101]
    v_pk_add_f32 v[210:211], v[210:211], v[102:103]
    v_pk_mul_f32 v[208:209], v[24:25], v[208:209] op_sel:[0,0] op_sel_hi:[0,1]
    v_pk_mul_f32 v[210:211], v[24:25], v[210:211] op_sel:[0,0] op_sel_hi:[0,1]
    ds_write_b128 v11, v[208:211] offset:64
    v_lshlrev_b32 v104, 16, v164
    v_and_b32 v105, 0xffff0000, v164
    v_lshlrev_b32 v106, 16, v165
    v_and_b32 v107, 0xffff0000, v165
    v_pk_add_f32 v[224:225], v[224:225], v[104:105]
    v_pk_add_f32 v[226:227], v[226:227], v[106:107]
    v_pk_mul_f32 v[224:225], v[24:25], v[224:225] op_sel:[0,0] op_sel_hi:[0,1]
    v_pk_mul_f32 v[226:227], v[24:25], v[226:227] op_sel:[0,0] op_sel_hi:[0,1]
    ds_write_b128 v11, v[224:227] offset:128
    v_lshlrev_b32 v108, 16, v166
    v_and_b32 v109, 0xffff0000, v166
    v_lshlrev_b32 v110, 16, v167
    v_and_b32 v111, 0xffff0000, v167
    v_pk_add_f32 v[240:241], v[240:241], v[108:109]
    v_pk_add_f32 v[242:243], v[242:243], v[110:111]
    v_pk_mul_f32 v[240:241], v[24:25], v[240:241] op_sel:[0,0] op_sel_hi:[0,1]
    v_pk_mul_f32 v[242:243], v[24:25], v[242:243] op_sel:[0,0] op_sel_hi:[0,1]
    ds_write_b128 v11, v[240:243] offset:192
    s_waitcnt lgkmcnt(0)
    s_barrier
    ds_read_b128 v[64:67], v3 offset:0
    ds_read_b128 v[68:71], v3 offset:34816
    s_waitcnt lgkmcnt(0)
    v_pk_add_f32 v[64:65], v[64:65], v[68:69]
    v_pk_add_f32 v[66:67], v[66:67], v[70:71]
    s_mov_b32 s50, 0
    buffer_store_dwordx4 v[64:67], v2, s[24:27], s50 offen sc1 nt
    v_lshlrev_b32 v96, 16, v168
    v_and_b32 v97, 0xffff0000, v168
    v_lshlrev_b32 v98, 16, v169
    v_and_b32 v99, 0xffff0000, v169
    v_pk_add_f32 v[196:197], v[196:197], v[96:97]
    v_pk_add_f32 v[198:199], v[198:199], v[98:99]
    v_pk_mul_f32 v[196:197], v[24:25], v[196:197] op_sel:[1,0] op_sel_hi:[1,1]
    v_pk_mul_f32 v[198:199], v[24:25], v[198:199] op_sel:[1,0] op_sel_hi:[1,1]
    ds_write_b128 v11, v[196:199] offset:4352
    v_lshlrev_b32 v100, 16, v170
    v_and_b32 v101, 0xffff0000, v170
    v_lshlrev_b32 v102, 16, v171
    v_and_b32 v103, 0xffff0000, v171
    v_pk_add_f32 v[212:213], v[212:213], v[100:101]
    v_pk_add_f32 v[214:215], v[214:215], v[102:103]
    v_pk_mul_f32 v[212:213], v[24:25], v[212:213] op_sel:[1,0] op_sel_hi:[1,1]
    v_pk_mul_f32 v[214:215], v[24:25], v[214:215] op_sel:[1,0] op_sel_hi:[1,1]
    ds_write_b128 v11, v[212:215] offset:4416
    v_lshlrev_b32 v104, 16, v172
    v_and_b32 v105, 0xffff0000, v172
    v_lshlrev_b32 v106, 16, v173
    v_and_b32 v107, 0xffff0000, v173
    v_pk_add_f32 v[228:229], v[228:229], v[104:105]
    v_pk_add_f32 v[230:231], v[230:231], v[106:107]
    v_pk_mul_f32 v[228:229], v[24:25], v[228:229] op_sel:[1,0] op_sel_hi:[1,1]
    v_pk_mul_f32 v[230:231], v[24:25], v[230:231] op_sel:[1,0] op_sel_hi:[1,1]
    ds_write_b128 v11, v[228:231] offset:4480
    v_lshlrev_b32 v108, 16, v174
    v_and_b32 v109, 0xffff0000, v174
    v_lshlrev_b32 v110, 16, v175
    v_and_b32 v111, 0xffff0000, v175
    v_pk_add_f32 v[244:245], v[244:245], v[108:109]
    v_pk_add_f32 v[246:247], v[246:247], v[110:111]
    v_pk_mul_f32 v[244:245], v[24:25], v[244:245] op_sel:[1,0] op_sel_hi:[1,1]
    v_pk_mul_f32 v[246:247], v[24:25], v[246:247] op_sel:[1,0] op_sel_hi:[1,1]
    ds_write_b128 v11, v[244:247] offset:4544
    s_waitcnt lgkmcnt(0)
    s_barrier
    ds_read_b128 v[72:75], v3 offset:4352
    ds_read_b128 v[76:79], v3 offset:39168
    s_waitcnt lgkmcnt(0)
    v_pk_add_f32 v[72:73], v[72:73], v[76:77]
    v_pk_add_f32 v[74:75], v[74:75], v[78:79]
    s_mov_b32 s50, 65536
    buffer_store_dwordx4 v[72:75], v2, s[24:27], s50 offen sc1 nt
    v_lshlrev_b32 v96, 16, v176
    v_and_b32 v97, 0xffff0000, v176
    v_lshlrev_b32 v98, 16, v177
    v_and_b32 v99, 0xffff0000, v177
    v_pk_add_f32 v[200:201], v[200:201], v[96:97]
    v_pk_add_f32 v[202:203], v[202:203], v[98:99]
    v_pk_mul_f32 v[200:201], v[26:27], v[200:201] op_sel:[0,0] op_sel_hi:[0,1]
    v_pk_mul_f32 v[202:203], v[26:27], v[202:203] op_sel:[0,0] op_sel_hi:[0,1]
    ds_write_b128 v11, v[200:203] offset:8704
    v_lshlrev_b32 v100, 16, v178
    v_and_b32 v101, 0xffff0000, v178
    v_lshlrev_b32 v102, 16, v179
    v_and_b32 v103, 0xffff0000, v179
    v_pk_add_f32 v[216:217], v[216:217], v[100:101]
    v_pk_add_f32 v[218:219], v[218:219], v[102:103]
    v_pk_mul_f32 v[216:217], v[26:27], v[216:217] op_sel:[0,0] op_sel_hi:[0,1]
    v_pk_mul_f32 v[218:219], v[26:27], v[218:219] op_sel:[0,0] op_sel_hi:[0,1]
    ds_write_b128 v11, v[216:219] offset:8768
    v_lshlrev_b32 v104, 16, v180
    v_and_b32 v105, 0xffff0000, v180
    v_lshlrev_b32 v106, 16, v181
    v_and_b32 v107, 0xffff0000, v181
    v_pk_add_f32 v[232:233], v[232:233], v[104:105]
    v_pk_add_f32 v[234:235], v[234:235], v[106:107]
    v_pk_mul_f32 v[232:233], v[26:27], v[232:233] op_sel:[0,0] op_sel_hi:[0,1]
    v_pk_mul_f32 v[234:235], v[26:27], v[234:235] op_sel:[0,0] op_sel_hi:[0,1]
    ds_write_b128 v11, v[232:235] offset:8832
    v_lshlrev_b32 v108, 16, v182
    v_and_b32 v109, 0xffff0000, v182
    v_lshlrev_b32 v110, 16, v183
    v_and_b32 v111, 0xffff0000, v183
    v_pk_add_f32 v[248:249], v[248:249], v[108:109]
    v_pk_add_f32 v[250:251], v[250:251], v[110:111]
    v_pk_mul_f32 v[248:249], v[26:27], v[248:249] op_sel:[0,0] op_sel_hi:[0,1]
    v_pk_mul_f32 v[250:251], v[26:27], v[250:251] op_sel:[0,0] op_sel_hi:[0,1]
    ds_write_b128 v11, v[248:251] offset:8896
    s_waitcnt lgkmcnt(0)
    s_barrier
    ds_read_b128 v[64:67], v3 offset:8704
    ds_read_b128 v[68:71], v3 offset:43520
    s_waitcnt lgkmcnt(0)
    v_pk_add_f32 v[64:65], v[64:65], v[68:69]
    v_pk_add_f32 v[66:67], v[66:67], v[70:71]
    s_mov_b32 s50, 131072
    buffer_store_dwordx4 v[64:67], v2, s[24:27], s50 offen sc1 nt
    v_lshlrev_b32 v96, 16, v184
    v_and_b32 v97, 0xffff0000, v184
    v_lshlrev_b32 v98, 16, v185
    v_and_b32 v99, 0xffff0000, v185
    v_pk_add_f32 v[204:205], v[204:205], v[96:97]
    v_pk_add_f32 v[206:207], v[206:207], v[98:99]
    v_pk_mul_f32 v[204:205], v[26:27], v[204:205] op_sel:[1,0] op_sel_hi:[1,1]
    v_pk_mul_f32 v[206:207], v[26:27], v[206:207] op_sel:[1,0] op_sel_hi:[1,1]
    ds_write_b128 v11, v[204:207] offset:13056
    v_lshlrev_b32 v100, 16, v186
    v_and_b32 v101, 0xffff0000, v186
    v_lshlrev_b32 v102, 16, v187
    v_and_b32 v103, 0xffff0000, v187
    v_pk_add_f32 v[220:221], v[220:221], v[100:101]
    v_pk_add_f32 v[222:223], v[222:223], v[102:103]
    v_pk_mul_f32 v[220:221], v[26:27], v[220:221] op_sel:[1,0] op_sel_hi:[1,1]
    v_pk_mul_f32 v[222:223], v[26:27], v[222:223] op_sel:[1,0] op_sel_hi:[1,1]
    ds_write_b128 v11, v[220:223] offset:13120
    v_lshlrev_b32 v104, 16, v188
    v_and_b32 v105, 0xffff0000, v188
    v_lshlrev_b32 v106, 16, v189
    v_and_b32 v107, 0xffff0000, v189
    v_pk_add_f32 v[236:237], v[236:237], v[104:105]
    v_pk_add_f32 v[238:239], v[238:239], v[106:107]
    v_pk_mul_f32 v[236:237], v[26:27], v[236:237] op_sel:[1,0] op_sel_hi:[1,1]
    v_pk_mul_f32 v[238:239], v[26:27], v[238:239] op_sel:[1,0] op_sel_hi:[1,1]
    ds_write_b128 v11, v[236:239] offset:13184
    v_lshlrev_b32 v108, 16, v190
    v_and_b32 v109, 0xffff0000, v190
    v_lshlrev_b32 v110, 16, v191
    v_and_b32 v111, 0xffff0000, v191
    v_pk_add_f32 v[252:253], v[252:253], v[108:109]
    v_pk_add_f32 v[254:255], v[254:255], v[110:111]
    v_pk_mul_f32 v[252:253], v[26:27], v[252:253] op_sel:[1,0] op_sel_hi:[1,1]
    v_pk_mul_f32 v[254:255], v[26:27], v[254:255] op_sel:[1,0] op_sel_hi:[1,1]
    ds_write_b128 v11, v[252:255] offset:13248
    s_waitcnt lgkmcnt(0)
    s_barrier
    ds_read_b128 v[72:75], v3 offset:13056
    ds_read_b128 v[76:79], v3 offset:47872
    s_waitcnt lgkmcnt(0)
    v_pk_add_f32 v[72:73], v[72:73], v[76:77]
    v_pk_add_f32 v[74:75], v[74:75], v[78:79]
    s_mov_b32 s50, 196608
    buffer_store_dwordx4 v[72:75], v2, s[24:27], s50 offen sc1 nt
L_end:
    s_endpgm
L_code_end:
.section .rodata,"a"
.p2align 6
.amdhsa_kernel gated_mix__ssm_conv_s5__ssm_conv_s5__prompt_kernel
  .amdhsa_next_free_vgpr 256
  .amdhsa_next_free_sgpr 102
  .amdhsa_accum_offset 256
  .amdhsa_group_segment_fixed_size 0
  .amdhsa_kernarg_size 176
  .amdhsa_user_sgpr_count 2
  .amdhsa_user_sgpr_kernarg_segment_ptr 1
  .amdhsa_system_sgpr_workgroup_id_x 1
  .amdhsa_float_denorm_mode_32 3
  .amdhsa_float_denorm_mode_16_64 3
.end_amdhsa_kernel
```
